```python
import torch

def _softmax(x, axis=-1):
    return torch.softmax(x, dim=axis)
def _gelu(x):
    return torch.nn.functional.gelu(x, approximate="tanh")
def _silu(x):
    return torch.nn.functional.silu(x)
def _sigmoid(x):
    return torch.sigmoid(x)
def _layernorm(x, axis=-1, eps=1e-5):
    m = x.mean(dim=axis, keepdim=True)
    v = x.var(dim=axis, keepdim=True, unbiased=False)
    return (x - m) / torch.sqrt(v + eps)
def _scatter_add(tgt, idx, src, axis=0):
    return tgt.clone().index_add_(axis, idx, src)
def _segment_sum(src, seg, n):
    out = torch.zeros((n,) + src.shape[1:], dtype=src.dtype)
    return out.index_add_(0, seg, src)
def _pad(x, pw):
    flat = tuple(v for pair in reversed(pw) for v in pair)
    return torch.nn.functional.pad(x, flat)

kernel_name = 'gated_mix__linear_kernel_hedgehog__dense_activation_gelu__prompt'

def setup_inputs():

    _w = (lambda a: (lambda t: t.to(torch.bfloat16) if t.is_floating_point() else t)(torch.as_tensor(a)))
    def _A_setup():
        B, S, D, H = 1, 2048, 512, 32
        Dh = D // H
        return {
            "x": _w((lambda *s: torch.randn(*s, dtype=torch.bfloat16) * 0.05)(B, S, D)),
            "wqkv": _w((lambda *s: torch.randn(*s, dtype=torch.bfloat16) * 0.8)(D, 3 * D)),
            "w_phi": _w((lambda *s: torch.randn(*s, dtype=torch.bfloat16) * 0.8)(H, Dh, Dh) * (Dh ** -0.5)),
            "wo": _w((lambda *s: torch.randn(*s, dtype=torch.bfloat16) * 0.05)(D, D)),
        }
    _A_in = _A_setup()

    def _B_setup():
        B, S, D, F = 1, 2048, 512, 1376
        return {
            "x": _w((lambda *s: torch.randn(*s, dtype=torch.bfloat16) * 0.05)(B, S, D)),
            "w1": _w((lambda *s: torch.randn(*s, dtype=torch.bfloat16) * 3.2)(D, F) * (D ** -0.5)),
            "b1": _w((lambda *s: torch.randn(*s, dtype=torch.bfloat16) * 3.2)(F) * 0.01),
            "w2": _w((lambda *s: torch.randn(*s, dtype=torch.bfloat16) * 0.2)(F, D) * (F ** -0.5)),
            "b2": _w((lambda *s: torch.randn(*s, dtype=torch.bfloat16) * 0.4)(D) * 0.01),
        }
    _B_in = _B_setup()

    return {
        "A_x": _A_in["x"],
        "A_wqkv": _A_in["wqkv"],
        "A_w_phi": _A_in["w_phi"],
        "A_wo": _A_in["wo"],
        "B_x": _B_in["x"],
        "B_w1": _B_in["w1"],
        "B_b1": _B_in["b1"],
        "B_w2": _B_in["w2"],
        "B_b2": _B_in["b2"],
        "gate_w": _w((lambda *s: torch.randn(*s, dtype=torch.bfloat16) * 0.05)(512) * 16.0),
    }

def reference(A_x, A_wqkv, A_w_phi, A_wo, B_x, B_w1, B_b1, B_w2, B_b2, gate_w):
    def _A_ref(x, wqkv, w_phi, wo):
        B, S, D = x.shape
        H = 32; Dh = D // H
        qkv = (lambda x, *d: x.permute(*d))((x @ wqkv).reshape(B, S, 3, H, Dh), 2, 0, 3, 1, 4)
        q, k, v = qkv[0], qkv[1], qkv[2]
        pq = torch.einsum("bhsd,hdf->bhsf", q, w_phi)
        pk = torch.einsum("bhsd,hdf->bhsf", k, w_phi)
        phi_q = torch.concatenate([_softmax(pq, axis=-1), _softmax(-pq, axis=-1)], axis=-1)
        phi_k = torch.concatenate([_softmax(pk, axis=-1), _softmax(-pk, axis=-1)], axis=-1)
        kv = torch.einsum("bhsf,bhsd->bhfd", phi_k, v)
        z  = torch.einsum("bhsf->bhf", phi_k)
        num = torch.einsum("bhqf,bhfd->bhqd", phi_q, kv)
        den = torch.einsum("bhqf,bhf->bhq", phi_q, z)[..., None] + 1e-6
        o = num / den
        return (lambda x, *d: x.permute(*d))(o, 0, 2, 1, 3).reshape(B, S, D) @ wo

    def _B_ref(x, w1, b1, w2, b2):
        h = torch.einsum("bsd,df->bsf", x, w1) + b1
        h = _gelu(h)
        return torch.einsum("bsf,fd->bsd", h, w2) + b2

    x = A_x
    g = _sigmoid((x * gate_w).sum(-1, keepdims=True))
    a = _A_ref(x, A_wqkv, A_w_phi, A_wo)
    b = _B_ref(x, B_w1, B_b1, B_w2, B_b2)
    return g * a + (1 - g) * b
```

```asm
; @launch grid=(256,1,1) block=(256,1,1) lds=163840
.amdgcn_target "amdgcn-amd-amdhsa--gfx950"
.text
.globl gated_mix__linear_kernel_hedgehog__dense_activation_gelu__prompt_kernel
.p2align 8
.type gated_mix__linear_kernel_hedgehog__dense_activation_gelu__prompt_kernel,@function
gated_mix__linear_kernel_hedgehog__dense_activation_gelu__prompt_kernel:
    s_lshr_b32 s61, s2, 8
    s_cbranch_scc1 L_exit
    s_load_dwordx16 s[4:19], s[0:1], 0
    v_lshrrev_b32 v2, 6, v0
    v_and_b32 v179, 63, v0
    v_readfirstlane_b32 s52, v2
    s_lshr_b32 s51, s2, 6
    s_cmp_eq_u32 s52, 3
    s_cbranch_scc0 L_b0pf
    s_getpc_b64 s[30:31]
L_pc:
    s_lshr_b32 s61, s2, 3
    v_and_b32 v1, 15, v0
    v_lshl_add_u32 v1, s61, 4, v1
    v_lshlrev_b32 v1, 7, v1
    v_min_u32 v1, L_codeend-L_pc-4, v1
    global_load_dword v255, v1, s[30:31]
    s_branch L_b1
L_b0pf:
    s_cmp_eq_u32 s52, 0
    s_cselect_b32 s61, 8, 6
    s_mul_i32 s64, s2, s61
    s_sub_u32 s61, s61, 1
    v_min_u32 v1, s61, v179
    v_add_u32 v1, s64, v1
    s_cmp_eq_u32 s52, 2
    s_movk_i32 s61, 2047
    s_cselect_b32 s61, 1375, s61
    v_min_u32 v1, s61, v1
    v_lshlrev_b32 v1, 10, v1
    s_waitcnt lgkmcnt(0)
    s_cselect_b64 s[30:31], s[18:19], s[6:7]
    s_cmp_eq_u32 s52, 0
    s_cselect_b64 s[30:31], s[4:5], s[30:31]
    global_load_dword v255, v1, s[30:31] offset:384
L_b1:
    s_load_dwordx8 s[20:27], s[0:1], 64
    s_load_dwordx2 s[28:29], s[0:1], 96
    s_and_b32 s62, s2, 1
    s_lshl_b32 s62, s62, 3
    s_bfe_u32 s53, s2, 0x30003
    s_add_u32 s53, s53, s62
    v_lshrrev_b32 v1, 3, v179
    v_lshlrev_b32 v1, 10, v1
    v_lshrrev_b32 v2, 4, v179
    v_and_b32 v3, 7, v179
    v_xor_b32 v2, v2, v3
    v_lshl_add_u32 v1, v2, 4, v1
    s_lshl_b32 s64, s53, 2
    s_add_u32 s64, s64, s52
    v_lshl_add_u32 v164, s64, 15, v1
    v_xor_b32 v1, 64, v164
    v_add_u32 v165, 7168, v1
    v_add_u32 v166, 14336, v164
    v_add_u32 v167, 21504, v1
    s_bitcmp0_b32 s51, 0
    s_cselect_b32 s61, 4, 5
    s_lshl_b32 s61, s61, 11
    s_mul_i32 s66, s52, s61
    s_lshl_b32 s61, s61, 2
    s_add_u32 m0, s66, s61
    s_mov_b32 s48, 0
    s_mov_b32 s49, 0
    s_mov_b32 s34, 2097152
    s_mov_b32 s35, 0x20000
    s_waitcnt lgkmcnt(0)
    s_mov_b64 s[32:33], s[4:5]
    buffer_load_dwordx4 v164, s[32:35], s48 offen offset:0 lds
    buffer_load_dwordx4 v165, s[32:35], s48 offen offset:1024 lds
    buffer_load_dwordx4 v166, s[32:35], s48 offen offset:2048 lds
    buffer_load_dwordx4 v167, s[32:35], s48 offen offset:3072 lds
    s_add_u32 m0, m0, 4096
    s_and_b32 s54, s2, 6
    s_mul_i32 s63, s54, 352
    s_lshr_b32 s62, s2, 7
    s_add_u32 s54, s54, s62
    s_mov_b32 s39, 0x20000
    v_bfe_u32 v1, v179, 2, 3
    v_lshl_add_u32 v2, s52, 4, v1
    v_lshrrev_b32 v232, 5, v179
    v_and_b32 v4, 3, v179
    v_lshlrev_b32 v4, 4, v4
    v_lshl_add_u32 v6, v232, 6, v4
    s_bitcmp0_b32 s51, 0
    s_cbranch_scc0 L_wf
    s_mov_b64 s[36:37], s[6:7]
    s_mov_b32 s38, 1572864
    v_mul_u32_u24 v2, 3072, v2
    s_lshl_b32 s63, s54, 7
    v_add3_u32 v2, v2, v6, s63
    v_add_u32 v168, 1024, v2
    buffer_load_dwordx4 v168, s[36:39], s49 offen offset:0 lds
    buffer_load_dwordx4 v168, s[36:39], s49 offen offset:1024 lds
    v_add_u32 v170, 23552, v2
    buffer_load_dwordx4 v170, s[36:39], s49 offen offset:2048 lds
    buffer_load_dwordx4 v170, s[36:39], s49 offen offset:3072 lds
    s_mov_b32 s50, 196608
    s_movk_i32 s61, 2048
    s_branch L_att
L_wf:
    s_cmp_eq_u32 s54, 7
    s_mov_b32 s61, 640
    s_cselect_b32 s61, 576, s61
    s_cmp_eq_u32 s51, 3
    s_cselect_b32 s61, s61, 0
    s_cselect_b32 s64, -64, 64
    s_add_u32 s3, s63, s61
    s_lshl_b32 s62, s64, 1
    s_sub_u32 s62, s62, 1024
    s_add_u32 s63, s3, 4096
    s_sub_u32 s36, s14, 4096
    s_subb_u32 s37, s15, 0
    s_mov_b32 s38, 1413120
    v_mul_u32_u24 v2, 2752, v2
    v_mad_i32_i24 v5, s64, v232, v4
    v_add3_u32 v168, v2, v5, s63
    buffer_load_dwordx4 v168, s[36:39], s49 offen offset:0 lds
    v_add_u32 v169, s62, v168
    buffer_load_dwordx4 v169, s[36:39], s49 offen offset:1024 lds
    s_cmp_eq_u32 s54, 6
    s_cselect_b32 s63, 3, s51
    s_lshr_b32 s55, s63, 1
    v_and_b32 v5, s55, v232
    v_lshlrev_b32 v5, 30, v5
    v_add3_u32 v170, v5, v169, s62
    buffer_load_dwordx4 v170, s[36:39], s49 offen offset:2048 lds
    v_add_u32 v171, 18944, v168
    buffer_load_dwordx4 v171, s[36:39], s49 offen offset:3072 lds
    s_add_u32 m0, m0, 4096
    v_add_u32 v172, 23040, v169
    buffer_load_dwordx4 v172, s[36:39], s49 offen offset:0 lds
    v_add3_u32 v173, v5, v172, s62
    buffer_load_dwordx4 v173, s[36:39], s49 offen offset:1024 lds
    s_mov_b32 s50, 176128
    s_movk_i32 s61, 3072
    s_mul_i32 s72, s52, 10240
    s_mov_b32 s48, 128
    s_mov_b32 s49, s50
    v_lshlrev_b32 v180, 4, v179
    v_and_b32 v233, 31, v179
    v_lshl_add_u32 v185, v1, 10, v6
    v_bfe_u32 v2, v179, 1, 3
    v_xor_b32 v2, v2, v232
    v_lshlrev_b32 v2, 4, v2
    v_lshl_add_u32 v2, v233, 7, v2
    v_add_u32 v174, s66, v2
    v_bfe_u32 v1, v179, 2, 2
    v_bfe_u32 v2, v179, 4, 1
    v_lshrrev_b32 v4, 1, v4
    v_lshl_add_u32 v4, v2, 5, v4
    v_lshl_add_u32 v216, v1, 6, v4
    v_mad_u32_u24 v175, s61, v232, v216
    v_mov_b32 v181, 0
    s_cmp_lt_u32 s52, 2
    s_cbranch_scc0 L_nogate
    s_mov_b32 s44, s22
    s_mov_b32 s45, s23
    s_mov_b32 s46, 1024
    s_mov_b32 s47, 0x20000
    s_lshl_b32 s61, s52, 10
    s_add_u32 m0, s61, 155648
    s_nop 0
    buffer_load_dwordx4 v180, s[44:47], s61 offen lds
L_nogate:
    v_lshlrev_b32 v7, 1, v233
    v_lshl_add_u32 v7, v232, 30, v7
    s_mov_b32 s44, s16
    s_mov_b32 s45, s17
    s_mov_b32 s46, 2752
    s_mov_b32 s47, 0x20000
    buffer_load_ushort v140, v7, s[44:47], s3 offen
    s_add_u32 s3, s3, s64
    buffer_load_ushort v144, v7, s[44:47], s3 offen
    s_add_u32 s3, s3, s64
    buffer_load_ushort v148, v7, s[44:47], s3 offen
    s_add_u32 s3, s3, s64
    buffer_load_ushort v152, v7, s[44:47], s3 offen
    s_add_u32 s3, s3, s64
    buffer_load_ushort v156, v7, s[44:47], s3 offen
    s_add_u32 s3, s3, s64
    buffer_load_ushort v160, v7, s[44:47], s3 offen
    s_lshl_b32 s0, s64, 5
    s_add_u32 s12, s28, 16777216
    s_addc_u32 s13, s29, 0
    s_lshl_b32 s61, s52, 10
    s_add_u32 s77, s61, s2
    s_cmp_lg_u32 s77, 64
    s_cbranch_scc1 L_non1
    s_load_dword s3, s[12:13], 0 glc
L_non1:
    v_add_u32 v176, 40960, v174
    v_add_u32 v177, 40960, v175
    s_add_u32 m0, s72, 81920
    v_bfe_u32 v4, v179, 2, 1
    v_xor_b32 v4, v4, v2
    buffer_load_dwordx4 v164, s[32:35], s48 offen offset:0 lds
    v_xor_b32 v5, v4, v232
    v_lshlrev_b32 v4, 10, v4
    buffer_load_dwordx4 v165, s[32:35], s48 offen offset:1024 lds
    v_lshl_add_u32 v4, v5, 4, v4
    v_add_u32 v178, 155648, v4
    buffer_load_dwordx4 v166, s[32:35], s48 offen offset:2048 lds
    v_mov_b32 v132, 0x3f80
    v_mov_b32 v133, 0
    buffer_load_dwordx4 v167, s[32:35], s48 offen offset:3072 lds
    v_mov_b32 v134, 0
    v_mov_b32 v135, 0
    s_add_u32 m0, m0, 4096
    v_mov_b32 v141, 0
    v_mov_b32 v142, 0
    buffer_load_dwordx4 v168, s[36:39], s49 offen offset:0 lds
    v_mov_b32 v143, 0
    v_mov_b32 v145, 0
    buffer_load_dwordx4 v169, s[36:39], s49 offen offset:1024 lds
    v_mov_b32 v146, 0
    v_mov_b32 v147, 0
    buffer_load_dwordx4 v170, s[36:39], s49 offen offset:2048 lds
    v_mov_b32 v149, 0
    v_mov_b32 v150, 0
    buffer_load_dwordx4 v171, s[36:39], s49 offen offset:3072 lds
    v_mov_b32 v151, 0
    v_mov_b32 v153, 0
    s_add_u32 m0, m0, 4096
    v_mov_b32 v154, 0
    v_mov_b32 v155, 0
    buffer_load_dwordx4 v172, s[36:39], s49 offen offset:0 lds
    v_mov_b32 v157, 0
    v_mov_b32 v158, 0
    buffer_load_dwordx4 v173, s[36:39], s49 offen offset:1024 lds
    v_mov_b32 v159, 0
    v_mov_b32 v161, 0
    v_mov_b32 v162, 0
    v_mov_b32 v163, 0
    s_mov_b32 s48, 256
    s_add_u32 s49, s49, s50
    s_waitcnt vmcnt(10)
    s_barrier
    v_mfma_f32_32x32x16_bf16 v[0:15], v[140:143], v[132:135], 0
    ds_read_b128 v[100:103], v176
    ds_read_b64_tr_b16 v[108:109], v177 offset:4096
    ds_read_b64_tr_b16 v[110:111], v177 offset:4352
    s_lshr_b32 s57, s2, 5
    s_and_b32 s56, s2, 7
    v_mfma_f32_32x32x16_bf16 v[16:31], v[144:147], v[132:135], 0
    ds_read_b64_tr_b16 v[112:113], v177 offset:4608
    ds_read_b64_tr_b16 v[114:115], v177 offset:4864
    ds_read_b64_tr_b16 v[116:117], v177 offset:5120
    v_xor_b32 v176, 32, v176
    s_add_u32 m0, s72, 0
    v_mfma_f32_32x32x16_bf16 v[32:47], v[148:151], v[132:135], 0
    ds_read_b64_tr_b16 v[118:119], v177 offset:5376
    ds_read_b64_tr_b16 v[120:121], v177 offset:5632
    ds_read_b64_tr_b16 v[122:123], v177 offset:5888
    buffer_load_dwordx4 v164, s[32:35], s48 offen offset:0 lds
    s_lshl_b32 s56, s56, 2
    ds_read_b64_tr_b16 v[124:125], v177 offset:6144
    v_mfma_f32_32x32x16_bf16 v[48:63], v[152:155], v[132:135], 0
    ds_read_b64_tr_b16 v[126:127], v177 offset:6400
    ds_read_b64_tr_b16 v[128:129], v177 offset:6656
    ds_read_b64_tr_b16 v[130:131], v177 offset:6912
    ds_read_b128 v[104:107], v178 offset:0
    s_bfe_u32 s62, s2, 0x20003
    v_mfma_f32_32x32x16_bf16 v[64:79], v[156:159], v[132:135], 0
    buffer_load_dwordx4 v165, s[32:35], s48 offen offset:1024 lds
    s_add_u32 s56, s56, s62
    v_min_u32 v186, 58, v179
    s_and_b32 s62, s2, 63
    s_lshl_b32 s61, s62, 2
    v_mfma_f32_32x32x16_bf16 v[80:95], v[160:163], v[132:135], 0
    s_add_u32 s61, s61, s52
    s_mul_i32 s61, s61, 59
    v_add_lshl_u32 v237, s61, v186, 7
    s_lshr_b32 s61, s2, 3
    s_waitcnt lgkmcnt(7)
    v_mfma_f32_32x32x16_bf16 v[0:15], v[108:111], v[100:103], v[0:15]
    ds_read_b128 v[132:135], v176
    ds_read_b64_tr_b16 v[140:141], v177 offset:14336
    ds_read_b64_tr_b16 v[142:143], v177 offset:14592
    buffer_load_dwordx4 v166, s[32:35], s48 offen offset:2048 lds
    s_mul_i32 s61, s61, 59
    v_mfma_f32_32x32x16_bf16 v[16:31], v[112:115], v[100:103], v[16:31]
    ds_read_b64_tr_b16 v[144:145], v177 offset:14848
    ds_read_b64_tr_b16 v[146:147], v177 offset:15104
    ds_read_b64_tr_b16 v[148:149], v177 offset:15360
    v_xor_b32 v176, 96, v176
    v_add_lshl_u32 v236, s61, v186, 10
    v_mfma_f32_32x32x16_bf16 v[32:47], v[116:119], v[100:103], v[32:47]
    ds_read_b64_tr_b16 v[150:151], v177 offset:15616
    ds_read_b64_tr_b16 v[152:153], v177 offset:15872
    ds_read_b64_tr_b16 v[154:155], v177 offset:16128
    s_waitcnt lgkmcnt(9)
    v_add_u32 v236, 384, v236
    v_mfma_f32_16x16x32_bf16 v[96:99], v[104:107], v[100:103], 0
    ds_read_b64_tr_b16 v[156:157], v177 offset:16384
    v_mfma_f32_32x32x16_bf16 v[48:63], v[120:123], v[100:103], v[48:63]
    ds_read_b64_tr_b16 v[158:159], v177 offset:16640
    ds_read_b64_tr_b16 v[160:161], v177 offset:16896
    ds_read_b64_tr_b16 v[162:163], v177 offset:17152
    ds_read_b128 v[136:139], v178 offset:32
    buffer_load_dwordx4 v167, s[32:35], s48 offen offset:3072 lds
    v_mfma_f32_32x32x16_bf16 v[64:79], v[124:127], v[100:103], v[64:79]
    s_add_u32 m0, m0, 4096
    s_mov_b32 s40, s28
    s_mov_b32 s41, s29
    s_mov_b32 s42, 268435456
    s_mov_b32 s43, 0x20000
    v_mfma_f32_32x32x16_bf16 v[80:95], v[128:131], v[100:103], v[80:95]
    buffer_load_dwordx4 v168, s[36:39], s49 offen offset:0 lds
    v_lshl_add_u32 v185, s57, 7, v185
    s_waitcnt lgkmcnt(7)
    v_mfma_f32_32x32x16_bf16 v[0:15], v[140:143], v[132:135], v[0:15]
    ds_read_b128 v[100:103], v176
    ds_read_b64_tr_b16 v[108:109], v177 offset:24576
    ds_read_b64_tr_b16 v[110:111], v177 offset:24832
    v_mfma_f32_32x32x16_bf16 v[16:31], v[144:147], v[132:135], v[16:31]
    ds_read_b64_tr_b16 v[112:113], v177 offset:25088
    ds_read_b64_tr_b16 v[114:115], v177 offset:25344
    ds_read_b64_tr_b16 v[116:117], v177 offset:25600
    v_xor_b32 v176, 32, v176
    buffer_load_dwordx4 v169, s[36:39], s49 offen offset:1024 lds
    v_mfma_f32_32x32x16_bf16 v[32:47], v[148:151], v[132:135], v[32:47]
    ds_read_b64_tr_b16 v[118:119], v177 offset:25856
    ds_read_b64_tr_b16 v[120:121], v177 offset:26112
    ds_read_b64_tr_b16 v[122:123], v177 offset:26368
    s_waitcnt lgkmcnt(9)
    v_mfma_f32_16x16x32_bf16 v[96:99], v[136:139], v[132:135], v[96:99]
    ds_read_b64_tr_b16 v[124:125], v177 offset:26624
    v_mfma_f32_32x32x16_bf16 v[48:63], v[152:155], v[132:135], v[48:63]
    ds_read_b64_tr_b16 v[126:127], v177 offset:26880
    ds_read_b64_tr_b16 v[128:129], v177 offset:27136
    ds_read_b64_tr_b16 v[130:131], v177 offset:27392
    ds_read_b128 v[104:107], v178 offset:64
    buffer_load_dwordx4 v170, s[36:39], s49 offen offset:2048 lds
    v_mfma_f32_32x32x16_bf16 v[64:79], v[156:159], v[132:135], v[64:79]
    v_mfma_f32_32x32x16_bf16 v[80:95], v[160:163], v[132:135], v[80:95]
    buffer_load_dwordx4 v171, s[36:39], s49 offen offset:3072 lds
    s_add_u32 m0, m0, 4096
    s_waitcnt lgkmcnt(7)
    v_mfma_f32_32x32x16_bf16 v[0:15], v[108:111], v[100:103], v[0:15]
    ds_read_b128 v[132:135], v176
    ds_read_b64_tr_b16 v[140:141], v177 offset:34816
    ds_read_b64_tr_b16 v[142:143], v177 offset:35072
    ds_read_b64_tr_b16 v[144:145], v177 offset:35328
    v_mfma_f32_32x32x16_bf16 v[16:31], v[112:115], v[100:103], v[16:31]
    ds_read_b64_tr_b16 v[146:147], v177 offset:35584
    ds_read_b64_tr_b16 v[148:149], v177 offset:35840
    ds_read_b64_tr_b16 v[150:151], v177 offset:36096
    ds_read_b64_tr_b16 v[152:153], v177 offset:36352
    buffer_load_dwordx4 v172, s[36:39], s49 offen offset:0 lds
    v_mfma_f32_32x32x16_bf16 v[32:47], v[116:119], v[100:103], v[32:47]
    ds_read_b64_tr_b16 v[154:155], v177 offset:36608
    ds_read_b64_tr_b16 v[156:157], v177 offset:36864
    ds_read_b64_tr_b16 v[158:159], v177 offset:37120
    ds_read_b64_tr_b16 v[160:161], v177 offset:37376
    s_waitcnt lgkmcnt(12)
    v_mfma_f32_16x16x32_bf16 v[96:99], v[104:107], v[100:103], v[96:99]
    ds_read_b64_tr_b16 v[162:163], v177 offset:37632
    ds_read_b128 v[136:139], v178 offset:96
    v_mfma_f32_32x32x16_bf16 v[48:63], v[120:123], v[100:103], v[48:63]
    buffer_load_dwordx4 v173, s[36:39], s49 offen offset:1024 lds
    v_mfma_f32_32x32x16_bf16 v[64:79], v[124:127], v[100:103], v[64:79]
    v_add_u32 v176, 81920, v174
    v_add_u32 v177, 81920, v175
    s_add_u32 s48, s48, 128
    s_add_u32 s49, s49, s50
    v_mfma_f32_32x32x16_bf16 v[80:95], v[128:131], v[100:103], v[80:95]
    s_waitcnt lgkmcnt(0)
    v_mfma_f32_32x32x16_bf16 v[0:15], v[140:143], v[132:135], v[0:15]
    s_waitcnt vmcnt(10)
    s_barrier
    ds_read_b128 v[100:103], v176
    ds_read_b64_tr_b16 v[108:109], v177 offset:4096
    ds_read_b64_tr_b16 v[110:111], v177 offset:4352
    v_mfma_f32_32x32x16_bf16 v[16:31], v[144:147], v[132:135], v[16:31]
    ds_read_b64_tr_b16 v[112:113], v177 offset:4608
    ds_read_b64_tr_b16 v[114:115], v177 offset:4864
    ds_read_b64_tr_b16 v[116:117], v177 offset:5120
    v_xor_b32 v176, 32, v176
    s_add_u32 m0, s72, 40960
    v_mfma_f32_32x32x16_bf16 v[32:47], v[148:151], v[132:135], v[32:47]
    ds_read_b64_tr_b16 v[118:119], v177 offset:5376
    ds_read_b64_tr_b16 v[120:121], v177 offset:5632
    ds_read_b64_tr_b16 v[122:123], v177 offset:5888
    buffer_load_dwordx4 v164, s[32:35], s48 offen offset:0 lds
    v_mfma_f32_16x16x32_bf16 v[96:99], v[136:139], v[132:135], v[96:99]
    ds_read_b64_tr_b16 v[124:125], v177 offset:6144
    v_mfma_f32_32x32x16_bf16 v[48:63], v[152:155], v[132:135], v[48:63]
    ds_read_b64_tr_b16 v[126:127], v177 offset:6400
    ds_read_b64_tr_b16 v[128:129], v177 offset:6656
    ds_read_b64_tr_b16 v[130:131], v177 offset:6912
    ds_read_b128 v[104:107], v178 offset:128
    v_mfma_f32_32x32x16_bf16 v[64:79], v[156:159], v[132:135], v[64:79]
    buffer_load_dwordx4 v165, s[32:35], s48 offen offset:1024 lds
    s_cmp_lg_u32 s77, 64
    s_cbranch_scc0 L_nonce
L_nonce_ok:
    s_and_b32 s61, s51, 1
    v_mfma_f32_32x32x16_bf16 v[80:95], v[160:163], v[132:135], v[80:95]
    s_lshl_b32 s61, s61, 3
    s_add_u32 s61, s61, s54
    s_lshl_b32 s62, s53, 4
    s_add_u32 s62, s62, s61
    s_waitcnt lgkmcnt(7)
    v_mfma_f32_32x32x16_bf16 v[0:15], v[108:111], v[100:103], v[0:15]
    ds_read_b128 v[132:135], v176
    ds_read_b64_tr_b16 v[140:141], v177 offset:14336
    ds_read_b64_tr_b16 v[142:143], v177 offset:14592
    buffer_load_dwordx4 v166, s[32:35], s48 offen offset:2048 lds
    s_lshl_b32 s62, s62, 2
    v_mfma_f32_32x32x16_bf16 v[16:31], v[112:115], v[100:103], v[16:31]
    ds_read_b64_tr_b16 v[144:145], v177 offset:14848
    ds_read_b64_tr_b16 v[146:147], v177 offset:15104
    ds_read_b64_tr_b16 v[148:149], v177 offset:15360
    v_xor_b32 v176, 96, v176
    s_add_u32 s62, s62, s52
    v_mfma_f32_32x32x16_bf16 v[32:47], v[116:119], v[100:103], v[32:47]
    ds_read_b64_tr_b16 v[150:151], v177 offset:15616
    ds_read_b64_tr_b16 v[152:153], v177 offset:15872
    ds_read_b64_tr_b16 v[154:155], v177 offset:16128
    s_waitcnt lgkmcnt(9)
    s_lshl_b32 s62, s62, 7
    v_mfma_f32_16x16x32_bf16 v[96:99], v[104:107], v[100:103], v[96:99]
    ds_read_b64_tr_b16 v[156:157], v177 offset:16384
    v_mfma_f32_32x32x16_bf16 v[48:63], v[120:123], v[100:103], v[48:63]
    ds_read_b64_tr_b16 v[158:159], v177 offset:16640
    ds_read_b64_tr_b16 v[160:161], v177 offset:16896
    ds_read_b64_tr_b16 v[162:163], v177 offset:17152
    ds_read_b128 v[136:139], v178 offset:160
    buffer_load_dwordx4 v167, s[32:35], s48 offen offset:3072 lds
    v_mfma_f32_32x32x16_bf16 v[64:79], v[124:127], v[100:103], v[64:79]
    s_add_u32 m0, m0, 4096
    s_add_u32 s73, s62, 9437184
    s_lshl_b32 s64, s53, 2
    s_add_u32 s64, s64, s52
    s_mul_i32 s75, s64, 122880
    v_mfma_f32_32x32x16_bf16 v[80:95], v[128:131], v[100:103], v[80:95]
    buffer_load_dwordx4 v168, s[36:39], s49 offen offset:0 lds
    s_lshl_b32 s1, s64, 8
    s_add_u32 s1, s1, 9961472
    v_lshlrev_b32 v254, 3, v233
    s_waitcnt lgkmcnt(7)
    v_mfma_f32_32x32x16_bf16 v[0:15], v[140:143], v[132:135], v[0:15]
    ds_read_b128 v[100:103], v176
    ds_read_b64_tr_b16 v[108:109], v177 offset:24576
    ds_read_b64_tr_b16 v[110:111], v177 offset:24832
    v_lshl_add_u32 v216, v232, 8, v216
    s_and_b32 s61, s52, 1
    v_mfma_f32_32x32x16_bf16 v[16:31], v[144:147], v[132:135], v[16:31]
    ds_read_b64_tr_b16 v[112:113], v177 offset:25088
    ds_read_b64_tr_b16 v[114:115], v177 offset:25344
    ds_read_b64_tr_b16 v[116:117], v177 offset:25600
    v_xor_b32 v176, 32, v176
    buffer_load_dwordx4 v169, s[36:39], s49 offen offset:1024 lds
    v_mfma_f32_32x32x16_bf16 v[32:47], v[148:151], v[132:135], v[32:47]
    ds_read_b64_tr_b16 v[118:119], v177 offset:25856
    ds_read_b64_tr_b16 v[120:121], v177 offset:26112
    ds_read_b64_tr_b16 v[122:123], v177 offset:26368
    s_waitcnt lgkmcnt(9)
    s_lshl_b32 s61, s61, 9
    v_mfma_f32_16x16x32_bf16 v[96:99], v[136:139], v[132:135], v[96:99]
    ds_read_b64_tr_b16 v[124:125], v177 offset:26624
    v_mfma_f32_32x32x16_bf16 v[48:63], v[152:155], v[132:135], v[48:63]
    ds_read_b64_tr_b16 v[126:127], v177 offset:26880
    ds_read_b64_tr_b16 v[128:129], v177 offset:27136
    ds_read_b64_tr_b16 v[130:131], v177 offset:27392
    ds_read_b128 v[104:107], v178 offset:192
    buffer_load_dwordx4 v170, s[36:39], s49 offen offset:2048 lds
    v_mfma_f32_32x32x16_bf16 v[64:79], v[156:159], v[132:135], v[64:79]
    s_add_u32 s61, s61, s72
    v_add_u32 v186, s61, v216
    v_add_u32 v216, 81920, v186
    v_xor_b32 v217, 512, v216
    v_add_u32 v218, 0, v186
    v_mfma_f32_32x32x16_bf16 v[80:95], v[160:163], v[132:135], v[80:95]
    buffer_load_dwordx4 v171, s[36:39], s49 offen offset:3072 lds
    s_add_u32 m0, m0, 4096
    v_xor_b32 v219, 512, v218
    v_add_u32 v220, 40960, v186
    s_waitcnt lgkmcnt(7)
    v_mfma_f32_32x32x16_bf16 v[0:15], v[108:111], v[100:103], v[0:15]
    ds_read_b128 v[132:135], v176
    ds_read_b64_tr_b16 v[140:141], v177 offset:34816
    ds_read_b64_tr_b16 v[142:143], v177 offset:35072
    ds_read_b64_tr_b16 v[144:145], v177 offset:35328
    v_xor_b32 v221, 512, v220
    v_mfma_f32_32x32x16_bf16 v[16:31], v[112:115], v[100:103], v[16:31]
    ds_read_b64_tr_b16 v[146:147], v177 offset:35584
    ds_read_b64_tr_b16 v[148:149], v177 offset:35840
    ds_read_b64_tr_b16 v[150:151], v177 offset:36096
    ds_read_b64_tr_b16 v[152:153], v177 offset:36352
    buffer_load_dwordx4 v172, s[36:39], s49 offen offset:0 lds
    v_mfma_f32_32x32x16_bf16 v[32:47], v[116:119], v[100:103], v[32:47]
    ds_read_b64_tr_b16 v[154:155], v177 offset:36608
    ds_read_b64_tr_b16 v[156:157], v177 offset:36864
    ds_read_b64_tr_b16 v[158:159], v177 offset:37120
    ds_read_b64_tr_b16 v[160:161], v177 offset:37376
    s_waitcnt lgkmcnt(12)
    v_mfma_f32_16x16x32_bf16 v[96:99], v[104:107], v[100:103], v[96:99]
    ds_read_b64_tr_b16 v[162:163], v177 offset:37632
    ds_read_b128 v[136:139], v178 offset:224
    v_mfma_f32_32x32x16_bf16 v[48:63], v[120:123], v[100:103], v[48:63]
    buffer_load_dwordx4 v173, s[36:39], s49 offen offset:1024 lds
    s_mul_i32 s58, s52, 360448
    s_add_u32 s60, s58, 163840
    v_mfma_f32_32x32x16_bf16 v[64:79], v[124:127], v[100:103], v[64:79]
    v_add_u32 v176, 0, v174
    v_add_u32 v177, 0, v175
    s_add_u32 s48, s48, 128
    s_add_u32 s49, s49, s50
    v_mfma_f32_32x32x16_bf16 v[80:95], v[128:131], v[100:103], v[80:95]
    s_cmp_lg_u32 s51, 1
    s_cbranch_scc1 L_pf1e
    s_mov_b32 s44, s18
    s_mov_b32 s45, s19
    s_mov_b32 s46, 1409024
    s_mov_b32 s47, 0x20000
    buffer_load_dword v255, v237, s[44:47], 0 offen
    v_subrev_u32 v237, 1409024, v237
    s_mov_b32 s44, s10
    s_mov_b32 s45, s11
    s_mov_b32 s46, 524288
    s_mov_b32 s47, 0x20000
    buffer_load_dword v255, v237, s[44:47], 0 offen
L_pf1e:
    s_waitcnt lgkmcnt(0)
    v_mfma_f32_32x32x16_bf16 v[0:15], v[140:143], v[132:135], v[0:15]
    s_waitcnt vmcnt(10)
    s_barrier
    ds_read_b128 v[100:103], v176
    ds_read_b64_tr_b16 v[108:109], v177 offset:4096
    ds_read_b64_tr_b16 v[110:111], v177 offset:4352
    v_mfma_f32_32x32x16_bf16 v[16:31], v[144:147], v[132:135], v[16:31]
    ds_read_b64_tr_b16 v[112:113], v177 offset:4608
    ds_read_b64_tr_b16 v[114:115], v177 offset:4864
    ds_read_b64_tr_b16 v[116:117], v177 offset:5120
    v_xor_b32 v176, 32, v176
    s_add_u32 m0, s72, 81920
    v_mfma_f32_32x32x16_bf16 v[32:47], v[148:151], v[132:135], v[32:47]
    ds_read_b64_tr_b16 v[118:119], v177 offset:5376
    ds_read_b64_tr_b16 v[120:121], v177 offset:5632
    ds_read_b64_tr_b16 v[122:123], v177 offset:5888
    buffer_load_dwordx4 v164, s[32:35], s48 offen offset:0 lds
    v_mfma_f32_16x16x32_bf16 v[96:99], v[136:139], v[132:135], v[96:99]
    ds_read_b64_tr_b16 v[124:125], v177 offset:6144
    v_mfma_f32_32x32x16_bf16 v[48:63], v[152:155], v[132:135], v[48:63]
    ds_read_b64_tr_b16 v[126:127], v177 offset:6400
    ds_read_b64_tr_b16 v[128:129], v177 offset:6656
    ds_read_b64_tr_b16 v[130:131], v177 offset:6912
    ds_read_b128 v[104:107], v178 offset:256
    v_mfma_f32_32x32x16_bf16 v[64:79], v[156:159], v[132:135], v[64:79]
    buffer_load_dwordx4 v165, s[32:35], s48 offen offset:1024 lds
    s_cmp_eq_u32 s52, 3
    s_cselect_b32 s60, 1073741824, s60
    s_cselect_b32 s61, 32768, 0
    s_sub_u32 s59, s58, s61
    v_mfma_f32_32x32x16_bf16 v[80:95], v[160:163], v[132:135], v[80:95]
    s_mov_b32 s70, 0x3fb8aa3b
    s_mov_b32 s71, s70
    v_and_b32 v193, 1, v179
    v_bfe_u32 v192, v179, 1, 1
    s_waitcnt lgkmcnt(7)
    v_mfma_f32_32x32x16_bf16 v[0:15], v[108:111], v[100:103], v[0:15]
    ds_read_b128 v[132:135], v176
    ds_read_b64_tr_b16 v[140:141], v177 offset:14336
    ds_read_b64_tr_b16 v[142:143], v177 offset:14592
    buffer_load_dwordx4 v166, s[32:35], s48 offen offset:2048 lds
    v_lshl_add_u32 v186, v192, 2, v193
    v_mfma_f32_32x32x16_bf16 v[16:31], v[112:115], v[100:103], v[16:31]
    ds_read_b64_tr_b16 v[144:145], v177 offset:14848
    ds_read_b64_tr_b16 v[146:147], v177 offset:15104
    ds_read_b64_tr_b16 v[148:149], v177 offset:15360
    v_xor_b32 v176, 96, v176
    v_lshlrev_b32 v225, 7, v186
    v_mfma_f32_32x32x16_bf16 v[32:47], v[116:119], v[100:103], v[32:47]
    ds_read_b64_tr_b16 v[150:151], v177 offset:15616
    ds_read_b64_tr_b16 v[152:153], v177 offset:15872
    ds_read_b64_tr_b16 v[154:155], v177 offset:16128
    s_waitcnt lgkmcnt(9)
    s_lshr_b32 s61, s52, 1
    v_mfma_f32_16x16x32_bf16 v[96:99], v[104:107], v[100:103], v[96:99]
    ds_read_b64_tr_b16 v[156:157], v177 offset:16384
    v_mfma_f32_32x32x16_bf16 v[48:63], v[120:123], v[100:103], v[48:63]
    ds_read_b64_tr_b16 v[158:159], v177 offset:16640
    ds_read_b64_tr_b16 v[160:161], v177 offset:16896
    ds_read_b64_tr_b16 v[162:163], v177 offset:17152
    ds_read_b128 v[136:139], v178 offset:288
    buffer_load_dwordx4 v167, s[32:35], s48 offen offset:3072 lds
    v_mfma_f32_32x32x16_bf16 v[64:79], v[124:127], v[100:103], v[64:79]
    s_add_u32 m0, m0, 4096
    s_lshl_b32 s62, s56, 1
    s_add_u32 s62, s62, s61
    s_mul_i32 s63, s62, 122880
    v_add_u32 v222, s63, v180
    v_mfma_f32_32x32x16_bf16 v[80:95], v[128:131], v[100:103], v[80:95]
    buffer_load_dwordx4 v168, s[36:39], s49 offen offset:0 lds
    s_xor_b32 s63, s62, 1
    s_mul_i32 s63, s63, 122880
    v_add_u32 v223, s63, v180
    s_waitcnt lgkmcnt(7)
    v_mfma_f32_32x32x16_bf16 v[0:15], v[140:143], v[132:135], v[0:15]
    ds_read_b128 v[100:103], v176
    ds_read_b64_tr_b16 v[108:109], v177 offset:24576
    ds_read_b64_tr_b16 v[110:111], v177 offset:24832
    s_lshl_b32 s62, s62, 15
    s_lshl_b32 s63, s57, 7
    v_mfma_f32_32x32x16_bf16 v[16:31], v[144:147], v[132:135], v[16:31]
    ds_read_b64_tr_b16 v[112:113], v177 offset:25088
    ds_read_b64_tr_b16 v[114:115], v177 offset:25344
    ds_read_b64_tr_b16 v[116:117], v177 offset:25600
    v_xor_b32 v176, 32, v176
    buffer_load_dwordx4 v169, s[36:39], s49 offen offset:1024 lds
    v_mfma_f32_32x32x16_bf16 v[32:47], v[148:151], v[132:135], v[32:47]
    ds_read_b64_tr_b16 v[118:119], v177 offset:25856
    ds_read_b64_tr_b16 v[120:121], v177 offset:26112
    ds_read_b64_tr_b16 v[122:123], v177 offset:26368
    s_waitcnt lgkmcnt(9)
    s_add_u32 s62, s62, s63
    v_mfma_f32_16x16x32_bf16 v[96:99], v[136:139], v[132:135], v[96:99]
    ds_read_b64_tr_b16 v[124:125], v177 offset:26624
    v_mfma_f32_32x32x16_bf16 v[48:63], v[152:155], v[132:135], v[48:63]
    ds_read_b64_tr_b16 v[126:127], v177 offset:26880
    ds_read_b64_tr_b16 v[128:129], v177 offset:27136
    ds_read_b64_tr_b16 v[130:131], v177 offset:27392
    ds_read_b128 v[104:107], v178 offset:320
    buffer_load_dwordx4 v170, s[36:39], s49 offen offset:2048 lds
    v_mfma_f32_32x32x16_bf16 v[64:79], v[156:159], v[132:135], v[64:79]
    s_and_b32 s63, s52, 1
    s_lshl_b32 s63, s63, 6
    s_add_u32 s62, s62, s63
    v_lshlrev_b32 v186, 10, v233
    v_lshl_add_u32 v186, v232, 4, v186
    v_mfma_f32_32x32x16_bf16 v[80:95], v[160:163], v[132:135], v[80:95]
    buffer_load_dwordx4 v171, s[36:39], s49 offen offset:3072 lds
    s_add_u32 m0, m0, 4096
    v_add_u32 v224, s62, v186
    v_lshlrev_b32 v186, 2, v233
    s_waitcnt lgkmcnt(7)
    v_mfma_f32_32x32x16_bf16 v[0:15], v[108:111], v[100:103], v[0:15]
    ds_read_b128 v[132:135], v176
    ds_read_b64_tr_b16 v[140:141], v177 offset:34816
    ds_read_b64_tr_b16 v[142:143], v177 offset:35072
    ds_read_b64_tr_b16 v[144:145], v177 offset:35328
    v_lshl_or_b32 v226, v232, 30, v186
    v_mfma_f32_32x32x16_bf16 v[16:31], v[112:115], v[100:103], v[16:31]
    ds_read_b64_tr_b16 v[146:147], v177 offset:35584
    ds_read_b64_tr_b16 v[148:149], v177 offset:35840
    ds_read_b64_tr_b16 v[150:151], v177 offset:36096
    ds_read_b64_tr_b16 v[152:153], v177 offset:36352
    buffer_load_dwordx4 v172, s[36:39], s49 offen offset:0 lds
    v_mfma_f32_32x32x16_bf16 v[32:47], v[116:119], v[100:103], v[32:47]
    ds_read_b64_tr_b16 v[154:155], v177 offset:36608
    ds_read_b64_tr_b16 v[156:157], v177 offset:36864
    ds_read_b64_tr_b16 v[158:159], v177 offset:37120
    ds_read_b64_tr_b16 v[160:161], v177 offset:37376
    s_waitcnt lgkmcnt(12)
    v_mfma_f32_16x16x32_bf16 v[96:99], v[104:107], v[100:103], v[96:99]
    ds_read_b64_tr_b16 v[162:163], v177 offset:37632
    ds_read_b128 v[136:139], v178 offset:352
    v_mfma_f32_32x32x16_bf16 v[48:63], v[120:123], v[100:103], v[48:63]
    buffer_load_dwordx4 v173, s[36:39], s49 offen offset:1024 lds
    s_lshr_b32 s61, s56, 1
    s_lshl_b32 s61, s61, 3
    s_add_u32 s61, s61, s52
    s_lshl_b32 s61, s61, 2
    v_mfma_f32_32x32x16_bf16 v[64:79], v[124:127], v[100:103], v[64:79]
    v_add_u32 v176, 40960, v174
    v_add_u32 v177, 40960, v175
    s_add_u32 s48, s48, 128
    s_add_u32 s49, s49, s50
    s_and_b32 s62, s56, 1
    v_mfma_f32_32x32x16_bf16 v[80:95], v[128:131], v[100:103], v[80:95]
    s_add_u32 s61, s61, s62
    s_lshl_b32 s61, s61, 8
    s_add_u32 s74, s61, 9437184
    s_xor_b32 s62, s52, 0
    s_waitcnt lgkmcnt(0)
    v_mfma_f32_32x32x16_bf16 v[0:15], v[140:143], v[132:135], v[0:15]
    s_waitcnt vmcnt(10)
    s_barrier
    ds_read_b128 v[100:103], v176
    ds_read_b64_tr_b16 v[108:109], v177 offset:4096
    ds_read_b64_tr_b16 v[110:111], v177 offset:4352
    v_mfma_f32_32x32x16_bf16 v[16:31], v[144:147], v[132:135], v[16:31]
    ds_read_b64_tr_b16 v[112:113], v177 offset:4608
    ds_read_b64_tr_b16 v[114:115], v177 offset:4864
    ds_read_b64_tr_b16 v[116:117], v177 offset:5120
    v_xor_b32 v176, 32, v176
    s_add_u32 m0, s72, 0
    v_mfma_f32_32x32x16_bf16 v[32:47], v[148:151], v[132:135], v[32:47]
    ds_read_b64_tr_b16 v[118:119], v177 offset:5376
    ds_read_b64_tr_b16 v[120:121], v177 offset:5632
    ds_read_b64_tr_b16 v[122:123], v177 offset:5888
    buffer_load_dwordx4 v164, s[32:35], s48 offen offset:0 lds
    s_mul_i32 s62, s62, 10240
    v_mfma_f32_16x16x32_bf16 v[96:99], v[136:139], v[132:135], v[96:99]
    ds_read_b64_tr_b16 v[124:125], v177 offset:6144
    v_mfma_f32_32x32x16_bf16 v[48:63], v[152:155], v[132:135], v[48:63]
    ds_read_b64_tr_b16 v[126:127], v177 offset:6400
    ds_read_b64_tr_b16 v[128:129], v177 offset:6656
    ds_read_b64_tr_b16 v[130:131], v177 offset:6912
    ds_read_b128 v[104:107], v178 offset:384
    s_add_u32 s62, s62, 0
    v_mfma_f32_32x32x16_bf16 v[64:79], v[156:159], v[132:135], v[64:79]
    buffer_load_dwordx4 v165, s[32:35], s48 offen offset:1024 lds
    v_add_u32 v227, s62, v180
    s_xor_b32 s62, s52, 0
    s_mul_i32 s62, s62, 10240
    s_add_u32 s62, s62, 40960
    v_mfma_f32_32x32x16_bf16 v[80:95], v[160:163], v[132:135], v[80:95]
    v_add_u32 v228, s62, v180
    s_xor_b32 s62, s52, 1
    s_mul_i32 s62, s62, 10240
    s_add_u32 s62, s62, 0
    s_waitcnt lgkmcnt(7)
    v_mfma_f32_32x32x16_bf16 v[0:15], v[108:111], v[100:103], v[0:15]
    ds_read_b128 v[132:135], v176
    ds_read_b64_tr_b16 v[140:141], v177 offset:14336
    ds_read_b64_tr_b16 v[142:143], v177 offset:14592
    buffer_load_dwordx4 v166, s[32:35], s48 offen offset:2048 lds
    v_add_u32 v229, s62, v180
    v_mfma_f32_32x32x16_bf16 v[16:31], v[112:115], v[100:103], v[16:31]
    ds_read_b64_tr_b16 v[144:145], v177 offset:14848
    ds_read_b64_tr_b16 v[146:147], v177 offset:15104
    ds_read_b64_tr_b16 v[148:149], v177 offset:15360
    v_xor_b32 v176, 96, v176
    s_xor_b32 s62, s52, 2
    v_mfma_f32_32x32x16_bf16 v[32:47], v[116:119], v[100:103], v[32:47]
    ds_read_b64_tr_b16 v[150:151], v177 offset:15616
    ds_read_b64_tr_b16 v[152:153], v177 offset:15872
    ds_read_b64_tr_b16 v[154:155], v177 offset:16128
    s_waitcnt lgkmcnt(9)
    s_mul_i32 s62, s62, 10240
    v_mfma_f32_16x16x32_bf16 v[96:99], v[104:107], v[100:103], v[96:99]
    ds_read_b64_tr_b16 v[156:157], v177 offset:16384
    v_mfma_f32_32x32x16_bf16 v[48:63], v[120:123], v[100:103], v[48:63]
    ds_read_b64_tr_b16 v[158:159], v177 offset:16640
    ds_read_b64_tr_b16 v[160:161], v177 offset:16896
    ds_read_b64_tr_b16 v[162:163], v177 offset:17152
    ds_read_b128 v[136:139], v178 offset:416
    buffer_load_dwordx4 v167, s[32:35], s48 offen offset:3072 lds
    v_mfma_f32_32x32x16_bf16 v[64:79], v[124:127], v[100:103], v[64:79]
    s_add_u32 m0, m0, 4096
    s_add_u32 s62, s62, 4096
    v_add_u32 v230, s62, v180
    s_xor_b32 s62, s52, 3
    s_mul_i32 s62, s62, 10240
    v_mfma_f32_32x32x16_bf16 v[80:95], v[128:131], v[100:103], v[80:95]
    buffer_load_dwordx4 v168, s[36:39], s49 offen offset:0 lds
    s_add_u32 s62, s62, 40960
    v_add_u32 v231, s62, v180
    v_lshlrev_b32 v186, 1, v233
    s_waitcnt lgkmcnt(7)
    v_mfma_f32_32x32x16_bf16 v[0:15], v[140:143], v[132:135], v[0:15]
    ds_read_b128 v[100:103], v176
    ds_read_b64_tr_b16 v[108:109], v177 offset:24576
    ds_read_b64_tr_b16 v[110:111], v177 offset:24832
    v_lshl_add_u32 v186, v232, 30, v186
    s_lshl_b32 s61, s57, 7
    v_mfma_f32_32x32x16_bf16 v[16:31], v[144:147], v[132:135], v[16:31]
    ds_read_b64_tr_b16 v[112:113], v177 offset:25088
    ds_read_b64_tr_b16 v[114:115], v177 offset:25344
    ds_read_b64_tr_b16 v[116:117], v177 offset:25600
    v_xor_b32 v176, 32, v176
    buffer_load_dwordx4 v169, s[36:39], s49 offen offset:1024 lds
    v_mfma_f32_32x32x16_bf16 v[32:47], v[148:151], v[132:135], v[32:47]
    ds_read_b64_tr_b16 v[118:119], v177 offset:25856
    ds_read_b64_tr_b16 v[120:121], v177 offset:26112
    ds_read_b64_tr_b16 v[122:123], v177 offset:26368
    s_waitcnt lgkmcnt(9)
    v_mfma_f32_16x16x32_bf16 v[96:99], v[136:139], v[132:135], v[96:99]
    ds_read_b64_tr_b16 v[124:125], v177 offset:26624
    v_mfma_f32_32x32x16_bf16 v[48:63], v[152:155], v[132:135], v[48:63]
    ds_read_b64_tr_b16 v[126:127], v177 offset:26880
    ds_read_b64_tr_b16 v[128:129], v177 offset:27136
    ds_read_b64_tr_b16 v[130:131], v177 offset:27392
    ds_read_b128 v[104:107], v178 offset:448
    buffer_load_dwordx4 v170, s[36:39], s49 offen offset:2048 lds
    v_mfma_f32_32x32x16_bf16 v[64:79], v[156:159], v[132:135], v[64:79]
    s_cmp_eq_u32 s52, 3
    s_cselect_b32 s61, s61, 1073741824
    s_mov_b32 s44, s20
    s_mov_b32 s45, s21
    s_mov_b32 s46, 1024
    s_mov_b32 s47, 0x20000
    buffer_load_ushort v234, v186, s[44:47], s61 offen offset:64
    buffer_load_ushort v235, v186, s[44:47], s61 offen
    v_mfma_f32_32x32x16_bf16 v[80:95], v[160:163], v[132:135], v[80:95]
    buffer_load_dwordx4 v171, s[36:39], s49 offen offset:3072 lds
    s_add_u32 m0, m0, 4096
    s_lshr_b32 s61, s54, 1
    s_mul_i32 s61, s61, 22528
    s_waitcnt lgkmcnt(7)
    v_mfma_f32_32x32x16_bf16 v[0:15], v[108:111], v[100:103], v[0:15]
    ds_read_b128 v[132:135], v176
    ds_read_b64_tr_b16 v[140:141], v177 offset:34816
    ds_read_b64_tr_b16 v[142:143], v177 offset:35072
    ds_read_b64_tr_b16 v[144:145], v177 offset:35328
    s_add_u32 s75, s75, s61
    v_mfma_f32_32x32x16_bf16 v[16:31], v[112:115], v[100:103], v[16:31]
    ds_read_b64_tr_b16 v[146:147], v177 offset:35584
    ds_read_b64_tr_b16 v[148:149], v177 offset:35840
    ds_read_b64_tr_b16 v[150:151], v177 offset:36096
    ds_read_b64_tr_b16 v[152:153], v177 offset:36352
    buffer_load_dwordx4 v172, s[36:39], s49 offen offset:0 lds
    v_mfma_f32_32x32x16_bf16 v[32:47], v[116:119], v[100:103], v[32:47]
    ds_read_b64_tr_b16 v[154:155], v177 offset:36608
    ds_read_b64_tr_b16 v[156:157], v177 offset:36864
    ds_read_b64_tr_b16 v[158:159], v177 offset:37120
    ds_read_b64_tr_b16 v[160:161], v177 offset:37376
    s_waitcnt lgkmcnt(12)
    v_mfma_f32_16x16x32_bf16 v[96:99], v[104:107], v[100:103], v[96:99]
    ds_read_b64_tr_b16 v[162:163], v177 offset:37632
    ds_read_b128 v[136:139], v178 offset:480
    v_mfma_f32_32x32x16_bf16 v[48:63], v[120:123], v[100:103], v[48:63]
    buffer_load_dwordx4 v173, s[36:39], s49 offen offset:1024 lds
    s_and_b32 s61, s54, 1
    s_mul_i32 s61, s61, 20480
    s_add_u32 s75, s75, s61
    v_mov_b32 v196, 0xc0135761
    v_mfma_f32_32x32x16_bf16 v[64:79], v[124:127], v[100:103], v[64:79]
    v_add_u32 v176, 81920, v174
    v_add_u32 v177, 81920, v175
    s_add_u32 s48, s48, 128
    s_add_u32 s49, s49, s50
    s_mov_b32 s68, 0xbdd2d3e8
    v_mfma_f32_32x32x16_bf16 v[80:95], v[128:131], v[100:103], v[80:95]
    s_mov_b32 s69, s68
    s_cmp_eq_u32 s54, 1
    s_cselect_b32 s1, s1, 1073741824
    v_lshl_or_b32 v254, v232, 30, v254
    s_waitcnt lgkmcnt(0)
    v_mfma_f32_32x32x16_bf16 v[0:15], v[140:143], v[132:135], v[0:15]
    s_waitcnt vmcnt(12)
    s_barrier
    ds_read_b128 v[100:103], v176
    ds_read_b64_tr_b16 v[108:109], v177 offset:4096
    ds_read_b64_tr_b16 v[110:111], v177 offset:4352
    v_mfma_f32_32x32x16_bf16 v[16:31], v[144:147], v[132:135], v[16:31]
    ds_read_b64_tr_b16 v[112:113], v177 offset:4608
    ds_read_b64_tr_b16 v[114:115], v177 offset:4864
    ds_read_b64_tr_b16 v[116:117], v177 offset:5120
    v_xor_b32 v176, 32, v176
    s_add_u32 m0, s72, 40960
    v_mfma_f32_32x32x16_bf16 v[32:47], v[148:151], v[132:135], v[32:47]
    ds_read_b64_tr_b16 v[118:119], v177 offset:5376
    ds_read_b64_tr_b16 v[120:121], v177 offset:5632
    ds_read_b64_tr_b16 v[122:123], v177 offset:5888
    buffer_load_dwordx4 v164, s[32:35], s48 offen offset:0 lds
    s_add_u32 s76, s73, 131072
    v_mfma_f32_16x16x32_bf16 v[96:99], v[136:139], v[132:135], v[96:99]
    ds_read_b64_tr_b16 v[124:125], v177 offset:6144
    v_mfma_f32_32x32x16_bf16 v[48:63], v[152:155], v[132:135], v[48:63]
    ds_read_b64_tr_b16 v[126:127], v177 offset:6400
    ds_read_b64_tr_b16 v[128:129], v177 offset:6656
    ds_read_b64_tr_b16 v[130:131], v177 offset:6912
    ds_read_b128 v[104:107], v178 offset:512
    v_mfma_f32_32x32x16_bf16 v[64:79], v[156:159], v[132:135], v[64:79]
    buffer_load_dwordx4 v165, s[32:35], s48 offen offset:1024 lds
    v_mfma_f32_32x32x16_bf16 v[80:95], v[160:163], v[132:135], v[80:95]
    s_waitcnt lgkmcnt(7)
    v_mfma_f32_32x32x16_bf16 v[0:15], v[108:111], v[100:103], v[0:15]
    ds_read_b128 v[132:135], v176
    ds_read_b64_tr_b16 v[140:141], v177 offset:14336
    ds_read_b64_tr_b16 v[142:143], v177 offset:14592
    buffer_load_dwordx4 v166, s[32:35], s48 offen offset:2048 lds
    v_mfma_f32_32x32x16_bf16 v[16:31], v[112:115], v[100:103], v[16:31]
    ds_read_b64_tr_b16 v[144:145], v177 offset:14848
    ds_read_b64_tr_b16 v[146:147], v177 offset:15104
    ds_read_b64_tr_b16 v[148:149], v177 offset:15360
    v_xor_b32 v176, 96, v176
    v_mfma_f32_32x32x16_bf16 v[32:47], v[116:119], v[100:103], v[32:47]
    ds_read_b64_tr_b16 v[150:151], v177 offset:15616
    ds_read_b64_tr_b16 v[152:153], v177 offset:15872
    ds_read_b64_tr_b16 v[154:155], v177 offset:16128
    s_waitcnt lgkmcnt(9)
    v_mfma_f32_16x16x32_bf16 v[96:99], v[104:107], v[100:103], v[96:99]
    ds_read_b64_tr_b16 v[156:157], v177 offset:16384
    v_mfma_f32_32x32x16_bf16 v[48:63], v[120:123], v[100:103], v[48:63]
    ds_read_b64_tr_b16 v[158:159], v177 offset:16640
    ds_read_b64_tr_b16 v[160:161], v177 offset:16896
    ds_read_b64_tr_b16 v[162:163], v177 offset:17152
    ds_read_b128 v[136:139], v178 offset:544
    buffer_load_dwordx4 v167, s[32:35], s48 offen offset:3072 lds
    v_mfma_f32_32x32x16_bf16 v[64:79], v[124:127], v[100:103], v[64:79]
    s_add_u32 m0, m0, 4096
    v_mfma_f32_32x32x16_bf16 v[80:95], v[128:131], v[100:103], v[80:95]
    buffer_load_dwordx4 v168, s[36:39], s49 offen offset:0 lds
    s_waitcnt lgkmcnt(7)
    v_mfma_f32_32x32x16_bf16 v[0:15], v[140:143], v[132:135], v[0:15]
    ds_read_b128 v[100:103], v176
    ds_read_b64_tr_b16 v[108:109], v177 offset:24576
    ds_read_b64_tr_b16 v[110:111], v177 offset:24832
    v_mfma_f32_32x32x16_bf16 v[16:31], v[144:147], v[132:135], v[16:31]
    ds_read_b64_tr_b16 v[112:113], v177 offset:25088
    ds_read_b64_tr_b16 v[114:115], v177 offset:25344
    ds_read_b64_tr_b16 v[116:117], v177 offset:25600
    v_xor_b32 v176, 32, v176
    buffer_load_dwordx4 v169, s[36:39], s49 offen offset:1024 lds
    v_mfma_f32_32x32x16_bf16 v[32:47], v[148:151], v[132:135], v[32:47]
    ds_read_b64_tr_b16 v[118:119], v177 offset:25856
    ds_read_b64_tr_b16 v[120:121], v177 offset:26112
    ds_read_b64_tr_b16 v[122:123], v177 offset:26368
    s_waitcnt lgkmcnt(9)
    v_mfma_f32_16x16x32_bf16 v[96:99], v[136:139], v[132:135], v[96:99]
    ds_read_b64_tr_b16 v[124:125], v177 offset:26624
    v_mfma_f32_32x32x16_bf16 v[48:63], v[152:155], v[132:135], v[48:63]
    ds_read_b64_tr_b16 v[126:127], v177 offset:26880
    ds_read_b64_tr_b16 v[128:129], v177 offset:27136
    ds_read_b64_tr_b16 v[130:131], v177 offset:27392
    ds_read_b128 v[104:107], v178 offset:576
    buffer_load_dwordx4 v170, s[36:39], s49 offen offset:2048 lds
    v_mfma_f32_32x32x16_bf16 v[64:79], v[156:159], v[132:135], v[64:79]
    v_mfma_f32_32x32x16_bf16 v[80:95], v[160:163], v[132:135], v[80:95]
    buffer_load_dwordx4 v171, s[36:39], s49 offen offset:3072 lds
    s_add_u32 m0, m0, 4096
    s_waitcnt lgkmcnt(7)
    v_mfma_f32_32x32x16_bf16 v[0:15], v[108:111], v[100:103], v[0:15]
    ds_read_b128 v[132:135], v176
    ds_read_b64_tr_b16 v[140:141], v177 offset:34816
    ds_read_b64_tr_b16 v[142:143], v177 offset:35072
    ds_read_b64_tr_b16 v[144:145], v177 offset:35328
    v_mfma_f32_32x32x16_bf16 v[16:31], v[112:115], v[100:103], v[16:31]
    ds_read_b64_tr_b16 v[146:147], v177 offset:35584
    ds_read_b64_tr_b16 v[148:149], v177 offset:35840
    ds_read_b64_tr_b16 v[150:151], v177 offset:36096
    ds_read_b64_tr_b16 v[152:153], v177 offset:36352
    buffer_load_dwordx4 v172, s[36:39], s49 offen offset:0 lds
    v_mfma_f32_32x32x16_bf16 v[32:47], v[116:119], v[100:103], v[32:47]
    ds_read_b64_tr_b16 v[154:155], v177 offset:36608
    ds_read_b64_tr_b16 v[156:157], v177 offset:36864
    ds_read_b64_tr_b16 v[158:159], v177 offset:37120
    ds_read_b64_tr_b16 v[160:161], v177 offset:37376
    s_waitcnt lgkmcnt(12)
    v_mfma_f32_16x16x32_bf16 v[96:99], v[104:107], v[100:103], v[96:99]
    ds_read_b64_tr_b16 v[162:163], v177 offset:37632
    ds_read_b128 v[136:139], v178 offset:608
    v_mfma_f32_32x32x16_bf16 v[48:63], v[120:123], v[100:103], v[48:63]
    buffer_load_dwordx4 v173, s[36:39], s49 offen offset:1024 lds
    v_mfma_f32_32x32x16_bf16 v[64:79], v[124:127], v[100:103], v[64:79]
    v_add_u32 v176, 0, v174
    v_add_u32 v177, 0, v175
    s_add_u32 s48, s48, 128
    s_add_u32 s49, s49, s50
    v_mfma_f32_32x32x16_bf16 v[80:95], v[128:131], v[100:103], v[80:95]
    s_waitcnt lgkmcnt(0)
    v_mfma_f32_32x32x16_bf16 v[0:15], v[140:143], v[132:135], v[0:15]
    s_waitcnt vmcnt(10)
    s_barrier
    ds_read_b128 v[100:103], v176
    ds_read_b64_tr_b16 v[108:109], v177 offset:4096
    ds_read_b64_tr_b16 v[110:111], v177 offset:4352
    v_mfma_f32_32x32x16_bf16 v[16:31], v[144:147], v[132:135], v[16:31]
    ds_read_b64_tr_b16 v[112:113], v177 offset:4608
    ds_read_b64_tr_b16 v[114:115], v177 offset:4864
    ds_read_b64_tr_b16 v[116:117], v177 offset:5120
    v_xor_b32 v176, 32, v176
    s_add_u32 m0, s72, 81920
    v_mfma_f32_32x32x16_bf16 v[32:47], v[148:151], v[132:135], v[32:47]
    ds_read_b64_tr_b16 v[118:119], v177 offset:5376
    ds_read_b64_tr_b16 v[120:121], v177 offset:5632
    ds_read_b64_tr_b16 v[122:123], v177 offset:5888
    buffer_load_dwordx4 v164, s[32:35], s48 offen offset:0 lds
    v_add_u32 v164, 0, v185
    v_mfma_f32_16x16x32_bf16 v[96:99], v[136:139], v[132:135], v[96:99]
    ds_read_b64_tr_b16 v[124:125], v177 offset:6144
    v_mfma_f32_32x32x16_bf16 v[48:63], v[152:155], v[132:135], v[48:63]
    ds_read_b64_tr_b16 v[126:127], v177 offset:6400
    ds_read_b64_tr_b16 v[128:129], v177 offset:6656
    ds_read_b64_tr_b16 v[130:131], v177 offset:6912
    ds_read_b128 v[104:107], v178 offset:640
    v_mfma_f32_32x32x16_bf16 v[64:79], v[156:159], v[132:135], v[64:79]
    buffer_load_dwordx4 v165, s[32:35], s48 offen offset:1024 lds
    v_add_u32 v165, 7168, v185
    v_mfma_f32_32x32x16_bf16 v[80:95], v[160:163], v[132:135], v[80:95]
    s_waitcnt lgkmcnt(7)
    v_mfma_f32_32x32x16_bf16 v[0:15], v[108:111], v[100:103], v[0:15]
    ds_read_b128 v[132:135], v176
    ds_read_b64_tr_b16 v[140:141], v177 offset:14336
    ds_read_b64_tr_b16 v[142:143], v177 offset:14592
    buffer_load_dwordx4 v166, s[32:35], s48 offen offset:2048 lds
    v_add_u32 v166, 14336, v185
    v_mfma_f32_32x32x16_bf16 v[16:31], v[112:115], v[100:103], v[16:31]
    ds_read_b64_tr_b16 v[144:145], v177 offset:14848
    ds_read_b64_tr_b16 v[146:147], v177 offset:15104
    ds_read_b64_tr_b16 v[148:149], v177 offset:15360
    v_xor_b32 v176, 96, v176
    v_mfma_f32_32x32x16_bf16 v[32:47], v[116:119], v[100:103], v[32:47]
    ds_read_b64_tr_b16 v[150:151], v177 offset:15616
    ds_read_b64_tr_b16 v[152:153], v177 offset:15872
    ds_read_b64_tr_b16 v[154:155], v177 offset:16128
    s_waitcnt lgkmcnt(9)
    v_mfma_f32_16x16x32_bf16 v[96:99], v[104:107], v[100:103], v[96:99]
    ds_read_b64_tr_b16 v[156:157], v177 offset:16384
    v_mfma_f32_32x32x16_bf16 v[48:63], v[120:123], v[100:103], v[48:63]
    ds_read_b64_tr_b16 v[158:159], v177 offset:16640
    ds_read_b64_tr_b16 v[160:161], v177 offset:16896
    ds_read_b64_tr_b16 v[162:163], v177 offset:17152
    ds_read_b128 v[136:139], v178 offset:672
    buffer_load_dwordx4 v167, s[32:35], s48 offen offset:3072 lds
    v_add_u32 v167, 21504, v185
    v_mfma_f32_32x32x16_bf16 v[64:79], v[124:127], v[100:103], v[64:79]
    s_add_u32 m0, m0, 4096
    v_mfma_f32_32x32x16_bf16 v[80:95], v[128:131], v[100:103], v[80:95]
    buffer_load_dwordx4 v168, s[36:39], s49 offen offset:0 lds
    v_add_u32 v168, 32768, v185
    s_waitcnt lgkmcnt(7)
    v_mfma_f32_32x32x16_bf16 v[0:15], v[140:143], v[132:135], v[0:15]
    ds_read_b128 v[100:103], v176
    ds_read_b64_tr_b16 v[108:109], v177 offset:24576
    ds_read_b64_tr_b16 v[110:111], v177 offset:24832
    v_mfma_f32_32x32x16_bf16 v[16:31], v[144:147], v[132:135], v[16:31]
    ds_read_b64_tr_b16 v[112:113], v177 offset:25088
    ds_read_b64_tr_b16 v[114:115], v177 offset:25344
    ds_read_b64_tr_b16 v[116:117], v177 offset:25600
    v_xor_b32 v176, 32, v176
    buffer_load_dwordx4 v169, s[36:39], s49 offen offset:1024 lds
    v_add_u32 v169, 39936, v185
    v_mfma_f32_32x32x16_bf16 v[32:47], v[148:151], v[132:135], v[32:47]
    ds_read_b64_tr_b16 v[118:119], v177 offset:25856
    ds_read_b64_tr_b16 v[120:121], v177 offset:26112
    ds_read_b64_tr_b16 v[122:123], v177 offset:26368
    s_waitcnt lgkmcnt(9)
    v_mfma_f32_16x16x32_bf16 v[96:99], v[136:139], v[132:135], v[96:99]
    ds_read_b64_tr_b16 v[124:125], v177 offset:26624
    v_mfma_f32_32x32x16_bf16 v[48:63], v[152:155], v[132:135], v[48:63]
    ds_read_b64_tr_b16 v[126:127], v177 offset:26880
    ds_read_b64_tr_b16 v[128:129], v177 offset:27136
    ds_read_b64_tr_b16 v[130:131], v177 offset:27392
    ds_read_b128 v[104:107], v178 offset:704
    buffer_load_dwordx4 v170, s[36:39], s49 offen offset:2048 lds
    v_add_u32 v170, 47104, v185
    v_mfma_f32_32x32x16_bf16 v[64:79], v[156:159], v[132:135], v[64:79]
    v_mfma_f32_32x32x16_bf16 v[80:95], v[160:163], v[132:135], v[80:95]
    buffer_load_dwordx4 v171, s[36:39], s49 offen offset:3072 lds
    v_add_u32 v171, 54272, v185
    s_add_u32 m0, m0, 4096
    s_waitcnt lgkmcnt(7)
    v_mfma_f32_32x32x16_bf16 v[0:15], v[108:111], v[100:103], v[0:15]
    ds_read_b128 v[132:135], v176
    ds_read_b64_tr_b16 v[140:141], v177 offset:34816
    ds_read_b64_tr_b16 v[142:143], v177 offset:35072
    ds_read_b64_tr_b16 v[144:145], v177 offset:35328
    v_mfma_f32_32x32x16_bf16 v[16:31], v[112:115], v[100:103], v[16:31]
    ds_read_b64_tr_b16 v[146:147], v177 offset:35584
    ds_read_b64_tr_b16 v[148:149], v177 offset:35840
    ds_read_b64_tr_b16 v[150:151], v177 offset:36096
    ds_read_b64_tr_b16 v[152:153], v177 offset:36352
    buffer_load_dwordx4 v172, s[36:39], s49 offen offset:0 lds
    v_add_u32 v172, 65536, v185
    v_mfma_f32_32x32x16_bf16 v[32:47], v[116:119], v[100:103], v[32:47]
    ds_read_b64_tr_b16 v[154:155], v177 offset:36608
    ds_read_b64_tr_b16 v[156:157], v177 offset:36864
    ds_read_b64_tr_b16 v[158:159], v177 offset:37120
    ds_read_b64_tr_b16 v[160:161], v177 offset:37376
    s_waitcnt lgkmcnt(12)
    v_mfma_f32_16x16x32_bf16 v[96:99], v[104:107], v[100:103], v[96:99]
    ds_read_b64_tr_b16 v[162:163], v177 offset:37632
    ds_read_b128 v[136:139], v178 offset:736
    v_mfma_f32_32x32x16_bf16 v[48:63], v[120:123], v[100:103], v[48:63]
    buffer_load_dwordx4 v173, s[36:39], s49 offen offset:1024 lds
    v_add_u32 v173, 72704, v185
    v_mfma_f32_32x32x16_bf16 v[64:79], v[124:127], v[100:103], v[64:79]
    v_add_u32 v176, 40960, v174
    v_add_u32 v177, 40960, v175
    s_add_u32 s48, s58, 0
    s_add_u32 s49, s58, 0
    v_mfma_f32_32x32x16_bf16 v[80:95], v[128:131], v[100:103], v[80:95]
    s_cmp_lg_u32 s52, 1
    s_cbranch_scc1 L_pf2e
    s_mov_b32 s44, s18
    s_mov_b32 s45, s19
    s_mov_b32 s46, 1409024
    s_mov_b32 s47, 0x20000
    buffer_load_dword v255, v236, s[44:47], 0 offen
    v_subrev_u32 v236, 1409024, v236
    s_mov_b32 s44, s10
    s_mov_b32 s45, s11
    s_mov_b32 s46, 524288
    s_mov_b32 s47, 0x20000
    buffer_load_dword v255, v236, s[44:47], 0 offen
L_pf2e:
    global_load_dword v184, v181, s[26:27] sc1
    s_mov_b32 s32, s18
    s_mov_b32 s33, s19
    s_mov_b32 s34, 1409024
    s_mov_b32 s35, 0x20000
    s_waitcnt lgkmcnt(0)
    v_mfma_f32_32x32x16_bf16 v[0:15], v[140:143], v[132:135], v[0:15]
    s_waitcnt vmcnt(11)
    s_barrier
    ds_read_b128 v[100:103], v176
    ds_read_b64_tr_b16 v[108:109], v177 offset:4096
    ds_read_b64_tr_b16 v[110:111], v177 offset:4352
    v_mfma_f32_32x32x16_bf16 v[16:31], v[144:147], v[132:135], v[16:31]
    ds_read_b64_tr_b16 v[112:113], v177 offset:4608
    ds_read_b64_tr_b16 v[114:115], v177 offset:4864
    ds_read_b64_tr_b16 v[116:117], v177 offset:5120
    v_xor_b32 v176, 32, v176
    s_add_u32 m0, s72, 0
    v_mfma_f32_32x32x16_bf16 v[32:47], v[148:151], v[132:135], v[32:47]
    ds_read_b64_tr_b16 v[118:119], v177 offset:5376
    ds_read_b64_tr_b16 v[120:121], v177 offset:5632
    ds_read_b64_tr_b16 v[122:123], v177 offset:5888
    buffer_load_dwordx4 v164, s[32:35], s48 offen offset:0 lds
    v_mfma_f32_16x16x32_bf16 v[96:99], v[136:139], v[132:135], v[96:99]
    ds_read_b64_tr_b16 v[124:125], v177 offset:6144
    v_mfma_f32_32x32x16_bf16 v[48:63], v[152:155], v[132:135], v[48:63]
    ds_read_b64_tr_b16 v[126:127], v177 offset:6400
    ds_read_b64_tr_b16 v[128:129], v177 offset:6656
    ds_read_b64_tr_b16 v[130:131], v177 offset:6912
    ds_read_b128 v[104:107], v178 offset:768
    v_mfma_f32_32x32x16_bf16 v[64:79], v[156:159], v[132:135], v[64:79]
    buffer_load_dwordx4 v165, s[32:35], s48 offen offset:1024 lds
    v_mfma_f32_32x32x16_bf16 v[80:95], v[160:163], v[132:135], v[80:95]
    s_waitcnt lgkmcnt(7)
    v_mfma_f32_32x32x16_bf16 v[0:15], v[108:111], v[100:103], v[0:15]
    ds_read_b128 v[132:135], v176
    ds_read_b64_tr_b16 v[140:141], v177 offset:14336
    ds_read_b64_tr_b16 v[142:143], v177 offset:14592
    buffer_load_dwordx4 v166, s[32:35], s48 offen offset:2048 lds
    v_mfma_f32_32x32x16_bf16 v[16:31], v[112:115], v[100:103], v[16:31]
    ds_read_b64_tr_b16 v[144:145], v177 offset:14848
    ds_read_b64_tr_b16 v[146:147], v177 offset:15104
    ds_read_b64_tr_b16 v[148:149], v177 offset:15360
    v_xor_b32 v176, 96, v176
    v_mfma_f32_32x32x16_bf16 v[32:47], v[116:119], v[100:103], v[32:47]
    ds_read_b64_tr_b16 v[150:151], v177 offset:15616
    ds_read_b64_tr_b16 v[152:153], v177 offset:15872
    ds_read_b64_tr_b16 v[154:155], v177 offset:16128
    s_waitcnt lgkmcnt(9)
    v_mfma_f32_16x16x32_bf16 v[96:99], v[104:107], v[100:103], v[96:99]
    ds_read_b64_tr_b16 v[156:157], v177 offset:16384
    v_mfma_f32_32x32x16_bf16 v[48:63], v[120:123], v[100:103], v[48:63]
    ds_read_b64_tr_b16 v[158:159], v177 offset:16640
    ds_read_b64_tr_b16 v[160:161], v177 offset:16896
    ds_read_b64_tr_b16 v[162:163], v177 offset:17152
    ds_read_b128 v[136:139], v178 offset:800
    buffer_load_dwordx4 v167, s[32:35], s48 offen offset:3072 lds
    v_mfma_f32_32x32x16_bf16 v[64:79], v[124:127], v[100:103], v[64:79]
    s_add_u32 m0, m0, 4096
    v_mfma_f32_32x32x16_bf16 v[80:95], v[128:131], v[100:103], v[80:95]
    buffer_load_dwordx4 v168, s[32:35], s49 offen offset:0 lds
    s_waitcnt lgkmcnt(7)
    v_mfma_f32_32x32x16_bf16 v[0:15], v[140:143], v[132:135], v[0:15]
    ds_read_b128 v[100:103], v176
    ds_read_b64_tr_b16 v[108:109], v177 offset:24576
    ds_read_b64_tr_b16 v[110:111], v177 offset:24832
    v_mfma_f32_32x32x16_bf16 v[16:31], v[144:147], v[132:135], v[16:31]
    ds_read_b64_tr_b16 v[112:113], v177 offset:25088
    ds_read_b64_tr_b16 v[114:115], v177 offset:25344
    ds_read_b64_tr_b16 v[116:117], v177 offset:25600
    v_xor_b32 v176, 32, v176
    buffer_load_dwordx4 v169, s[32:35], s49 offen offset:1024 lds
    v_mfma_f32_32x32x16_bf16 v[32:47], v[148:151], v[132:135], v[32:47]
    ds_read_b64_tr_b16 v[118:119], v177 offset:25856
    ds_read_b64_tr_b16 v[120:121], v177 offset:26112
    ds_read_b64_tr_b16 v[122:123], v177 offset:26368
    s_waitcnt lgkmcnt(9)
    v_mfma_f32_16x16x32_bf16 v[96:99], v[136:139], v[132:135], v[96:99]
    ds_read_b64_tr_b16 v[124:125], v177 offset:26624
    v_mfma_f32_32x32x16_bf16 v[48:63], v[152:155], v[132:135], v[48:63]
    ds_read_b64_tr_b16 v[126:127], v177 offset:26880
    ds_read_b64_tr_b16 v[128:129], v177 offset:27136
    ds_read_b64_tr_b16 v[130:131], v177 offset:27392
    ds_read_b128 v[104:107], v178 offset:832
    buffer_load_dwordx4 v170, s[32:35], s49 offen offset:2048 lds
    v_mfma_f32_32x32x16_bf16 v[64:79], v[156:159], v[132:135], v[64:79]
    v_mfma_f32_32x32x16_bf16 v[80:95], v[160:163], v[132:135], v[80:95]
    buffer_load_dwordx4 v171, s[32:35], s49 offen offset:3072 lds
    s_add_u32 m0, m0, 4096
    s_waitcnt lgkmcnt(7)
    v_mfma_f32_32x32x16_bf16 v[0:15], v[108:111], v[100:103], v[0:15]
    ds_read_b128 v[132:135], v176
    ds_read_b64_tr_b16 v[140:141], v177 offset:34816
    ds_read_b64_tr_b16 v[142:143], v177 offset:35072
    ds_read_b64_tr_b16 v[144:145], v177 offset:35328
    v_mfma_f32_32x32x16_bf16 v[16:31], v[112:115], v[100:103], v[16:31]
    ds_read_b64_tr_b16 v[146:147], v177 offset:35584
    ds_read_b64_tr_b16 v[148:149], v177 offset:35840
    ds_read_b64_tr_b16 v[150:151], v177 offset:36096
    ds_read_b64_tr_b16 v[152:153], v177 offset:36352
    buffer_load_dwordx4 v172, s[32:35], s49 offen offset:0 lds
    v_mfma_f32_32x32x16_bf16 v[32:47], v[116:119], v[100:103], v[32:47]
    ds_read_b64_tr_b16 v[154:155], v177 offset:36608
    ds_read_b64_tr_b16 v[156:157], v177 offset:36864
    ds_read_b64_tr_b16 v[158:159], v177 offset:37120
    ds_read_b64_tr_b16 v[160:161], v177 offset:37376
    s_waitcnt lgkmcnt(12)
    v_mfma_f32_16x16x32_bf16 v[96:99], v[104:107], v[100:103], v[96:99]
    ds_read_b64_tr_b16 v[162:163], v177 offset:37632
    ds_read_b128 v[136:139], v178 offset:864
    v_mfma_f32_32x32x16_bf16 v[48:63], v[120:123], v[100:103], v[48:63]
    buffer_load_dwordx4 v173, s[32:35], s49 offen offset:1024 lds
    v_mfma_f32_32x32x16_bf16 v[64:79], v[124:127], v[100:103], v[64:79]
    v_add_u32 v176, 81920, v174
    v_add_u32 v177, 81920, v175
    s_add_u32 s48, s58, 81920
    s_add_u32 s49, s58, 81920
    v_mfma_f32_32x32x16_bf16 v[80:95], v[128:131], v[100:103], v[80:95]
    s_sub_u32 s36, s10, 32768
    s_subb_u32 s37, s11, 0
    s_mov_b32 s38, 557056
    s_mov_b32 s39, 0x20000
    s_waitcnt lgkmcnt(0)
    v_mfma_f32_32x32x16_bf16 v[0:15], v[140:143], v[132:135], v[0:15]
    s_waitcnt vmcnt(11)
    s_barrier
    ds_read_b128 v[100:103], v176
    ds_read_b64_tr_b16 v[108:109], v177 offset:4096
    ds_read_b64_tr_b16 v[110:111], v177 offset:4352
    v_mfma_f32_32x32x16_bf16 v[16:31], v[144:147], v[132:135], v[16:31]
    ds_read_b64_tr_b16 v[112:113], v177 offset:4608
    ds_read_b64_tr_b16 v[114:115], v177 offset:4864
    ds_read_b64_tr_b16 v[116:117], v177 offset:5120
    v_xor_b32 v176, 32, v176
    s_add_u32 m0, s72, 40960
    v_mfma_f32_32x32x16_bf16 v[32:47], v[148:151], v[132:135], v[32:47]
    ds_read_b64_tr_b16 v[118:119], v177 offset:5376
    ds_read_b64_tr_b16 v[120:121], v177 offset:5632
    ds_read_b64_tr_b16 v[122:123], v177 offset:5888
    buffer_load_dwordx4 v164, s[32:35], s48 offen offset:0 lds
    v_mfma_f32_16x16x32_bf16 v[96:99], v[136:139], v[132:135], v[96:99]
    ds_read_b64_tr_b16 v[124:125], v177 offset:6144
    v_mfma_f32_32x32x16_bf16 v[48:63], v[152:155], v[132:135], v[48:63]
    ds_read_b64_tr_b16 v[126:127], v177 offset:6400
    ds_read_b64_tr_b16 v[128:129], v177 offset:6656
    ds_read_b64_tr_b16 v[130:131], v177 offset:6912
    ds_read_b128 v[104:107], v178 offset:896
    v_mfma_f32_32x32x16_bf16 v[64:79], v[156:159], v[132:135], v[64:79]
    buffer_load_dwordx4 v165, s[32:35], s48 offen offset:1024 lds
    v_mfma_f32_32x32x16_bf16 v[80:95], v[160:163], v[132:135], v[80:95]
    s_waitcnt lgkmcnt(7)
    v_mfma_f32_32x32x16_bf16 v[0:15], v[108:111], v[100:103], v[0:15]
    ds_read_b128 v[132:135], v176
    ds_read_b64_tr_b16 v[140:141], v177 offset:14336
    ds_read_b64_tr_b16 v[142:143], v177 offset:14592
    buffer_load_dwordx4 v166, s[32:35], s48 offen offset:2048 lds
    v_mfma_f32_32x32x16_bf16 v[16:31], v[112:115], v[100:103], v[16:31]
    ds_read_b64_tr_b16 v[144:145], v177 offset:14848
    ds_read_b64_tr_b16 v[146:147], v177 offset:15104
    ds_read_b64_tr_b16 v[148:149], v177 offset:15360
    v_xor_b32 v176, 96, v176
    v_mfma_f32_32x32x16_bf16 v[32:47], v[116:119], v[100:103], v[32:47]
    ds_read_b64_tr_b16 v[150:151], v177 offset:15616
    ds_read_b64_tr_b16 v[152:153], v177 offset:15872
    ds_read_b64_tr_b16 v[154:155], v177 offset:16128
    s_waitcnt lgkmcnt(9)
    v_mfma_f32_16x16x32_bf16 v[96:99], v[104:107], v[100:103], v[96:99]
    ds_read_b64_tr_b16 v[156:157], v177 offset:16384
    v_mfma_f32_32x32x16_bf16 v[48:63], v[120:123], v[100:103], v[48:63]
    ds_read_b64_tr_b16 v[158:159], v177 offset:16640
    ds_read_b64_tr_b16 v[160:161], v177 offset:16896
    ds_read_b64_tr_b16 v[162:163], v177 offset:17152
    ds_read_b128 v[136:139], v178 offset:928
    buffer_load_dwordx4 v167, s[32:35], s48 offen offset:3072 lds
    v_mfma_f32_32x32x16_bf16 v[64:79], v[124:127], v[100:103], v[64:79]
    s_add_u32 m0, m0, 4096
    v_mfma_f32_32x32x16_bf16 v[80:95], v[128:131], v[100:103], v[80:95]
    buffer_load_dwordx4 v168, s[32:35], s49 offen offset:0 lds
    s_waitcnt lgkmcnt(7)
    v_mfma_f32_32x32x16_bf16 v[0:15], v[140:143], v[132:135], v[0:15]
    ds_read_b128 v[100:103], v176
    ds_read_b64_tr_b16 v[108:109], v177 offset:24576
    ds_read_b64_tr_b16 v[110:111], v177 offset:24832
    v_mfma_f32_32x32x16_bf16 v[16:31], v[144:147], v[132:135], v[16:31]
    ds_read_b64_tr_b16 v[112:113], v177 offset:25088
    ds_read_b64_tr_b16 v[114:115], v177 offset:25344
    ds_read_b64_tr_b16 v[116:117], v177 offset:25600
    v_xor_b32 v176, 32, v176
    buffer_load_dwordx4 v169, s[32:35], s49 offen offset:1024 lds
    v_mfma_f32_32x32x16_bf16 v[32:47], v[148:151], v[132:135], v[32:47]
    ds_read_b64_tr_b16 v[118:119], v177 offset:25856
    ds_read_b64_tr_b16 v[120:121], v177 offset:26112
    ds_read_b64_tr_b16 v[122:123], v177 offset:26368
    s_waitcnt lgkmcnt(9)
    v_mfma_f32_16x16x32_bf16 v[96:99], v[136:139], v[132:135], v[96:99]
    ds_read_b64_tr_b16 v[124:125], v177 offset:26624
    v_mfma_f32_32x32x16_bf16 v[48:63], v[152:155], v[132:135], v[48:63]
    ds_read_b64_tr_b16 v[126:127], v177 offset:26880
    ds_read_b64_tr_b16 v[128:129], v177 offset:27136
    ds_read_b64_tr_b16 v[130:131], v177 offset:27392
    ds_read_b128 v[104:107], v178 offset:960
    buffer_load_dwordx4 v170, s[32:35], s49 offen offset:2048 lds
    v_mfma_f32_32x32x16_bf16 v[64:79], v[156:159], v[132:135], v[64:79]
    v_mfma_f32_32x32x16_bf16 v[80:95], v[160:163], v[132:135], v[80:95]
    buffer_load_dwordx4 v171, s[32:35], s49 offen offset:3072 lds
    s_add_u32 m0, m0, 4096
    s_waitcnt lgkmcnt(7)
    v_mfma_f32_32x32x16_bf16 v[0:15], v[108:111], v[100:103], v[0:15]
    ds_read_b128 v[132:135], v176
    ds_read_b64_tr_b16 v[140:141], v177 offset:34816
    ds_read_b64_tr_b16 v[142:143], v177 offset:35072
    ds_read_b64_tr_b16 v[144:145], v177 offset:35328
    v_mfma_f32_32x32x16_bf16 v[16:31], v[112:115], v[100:103], v[16:31]
    ds_read_b64_tr_b16 v[146:147], v177 offset:35584
    ds_read_b64_tr_b16 v[148:149], v177 offset:35840
    ds_read_b64_tr_b16 v[150:151], v177 offset:36096
    ds_read_b64_tr_b16 v[152:153], v177 offset:36352
    buffer_load_dwordx4 v172, s[32:35], s49 offen offset:0 lds
    v_mfma_f32_32x32x16_bf16 v[32:47], v[116:119], v[100:103], v[32:47]
    ds_read_b64_tr_b16 v[154:155], v177 offset:36608
    ds_read_b64_tr_b16 v[156:157], v177 offset:36864
    ds_read_b64_tr_b16 v[158:159], v177 offset:37120
    ds_read_b64_tr_b16 v[160:161], v177 offset:37376
    s_waitcnt lgkmcnt(12)
    v_mfma_f32_16x16x32_bf16 v[96:99], v[104:107], v[100:103], v[96:99]
    ds_read_b64_tr_b16 v[162:163], v177 offset:37632
    ds_read_b128 v[136:139], v178 offset:992
    v_mfma_f32_32x32x16_bf16 v[48:63], v[120:123], v[100:103], v[48:63]
    buffer_load_dwordx4 v173, s[32:35], s49 offen offset:1024 lds
    v_mfma_f32_32x32x16_bf16 v[64:79], v[124:127], v[100:103], v[64:79]
    v_mfma_f32_32x32x16_bf16 v[80:95], v[128:131], v[100:103], v[80:95]
    s_waitcnt lgkmcnt(0)
    v_mfma_f32_16x16x32_bf16 v[96:99], v[136:139], v[132:135], v[96:99]
    s_barrier
    v_mfma_f32_32x32x16_bf16 v[0:15], v[140:143], v[132:135], v[0:15]
    s_waitcnt vmcnt(20)
    v_readfirstlane_b32 s65, v184
    v_mfma_f32_32x32x16_bf16 v[16:31], v[144:147], v[132:135], v[16:31]
    s_cmp_eq_u32 s65, 0
    s_cbranch_scc1 L_tag3_r
L_tag3_ok:
    v_mfma_f32_32x32x16_bf16 v[32:47], v[148:151], v[132:135], v[32:47]
    s_nop 1
    v_mul_f32 v182, s70, v96
    v_mov_b32 v97, v184
    v_mfma_f32_32x32x16_bf16 v[48:63], v[152:155], v[132:135], v[48:63]
    v_exp_f32 v182, v182
    buffer_store_dwordx2 v[96:97], v254, s[40:43], s1 offen sc1
    v_mfma_f32_32x32x16_bf16 v[64:79], v[156:159], v[132:135], v[64:79]
    v_add_f32_e64 v182, 1.0, v182
    v_min_f32 v182, 0x7149f2ca, v182
    v_mfma_f32_32x32x16_bf16 v[80:95], v[160:163], v[132:135], v[80:95]
    v_pk_mul_f32 v[100:101], v[0:1], v[0:1]
    v_pk_mul_f32 v[102:103], v[2:3], v[2:3]
    v_pk_mul_f32 v[104:105], v[4:5], v[4:5]
    v_pk_mul_f32 v[106:107], v[6:7], v[6:7]
    v_pk_mul_f32 v[108:109], v[8:9], v[8:9]
    v_pk_mul_f32 v[110:111], v[10:11], v[10:11]
    v_pk_mul_f32 v[112:113], v[12:13], v[12:13]
    v_pk_mul_f32 v[114:115], v[14:15], v[14:15]
    v_pk_fma_f32 v[100:101], v[100:101], s[68:69], v[196:197] op_sel_hi:[1,1,0]
    v_pk_fma_f32 v[102:103], v[102:103], s[68:69], v[196:197] op_sel_hi:[1,1,0]
    v_pk_fma_f32 v[104:105], v[104:105], s[68:69], v[196:197] op_sel_hi:[1,1,0]
    v_pk_fma_f32 v[106:107], v[106:107], s[68:69], v[196:197] op_sel_hi:[1,1,0]
    v_pk_fma_f32 v[108:109], v[108:109], s[68:69], v[196:197] op_sel_hi:[1,1,0]
    v_pk_fma_f32 v[110:111], v[110:111], s[68:69], v[196:197] op_sel_hi:[1,1,0]
    v_pk_fma_f32 v[112:113], v[112:113], s[68:69], v[196:197] op_sel_hi:[1,1,0]
    v_pk_fma_f32 v[114:115], v[114:115], s[68:69], v[196:197] op_sel_hi:[1,1,0]
    v_pk_mul_f32 v[100:101], v[100:101], v[0:1]
    v_pk_mul_f32 v[102:103], v[102:103], v[2:3]
    v_pk_mul_f32 v[104:105], v[104:105], v[4:5]
    v_pk_mul_f32 v[106:107], v[106:107], v[6:7]
    v_pk_mul_f32 v[108:109], v[108:109], v[8:9]
    v_pk_mul_f32 v[110:111], v[110:111], v[10:11]
    v_pk_mul_f32 v[112:113], v[112:113], v[12:13]
    v_pk_mul_f32 v[114:115], v[114:115], v[14:15]
    v_exp_f32 v100, v100
    v_exp_f32 v101, v101
    v_exp_f32 v102, v102
    v_exp_f32 v103, v103
    v_exp_f32 v104, v104
    v_exp_f32 v105, v105
    v_exp_f32 v106, v106
    v_exp_f32 v107, v107
    v_exp_f32 v108, v108
    v_exp_f32 v109, v109
    v_exp_f32 v110, v110
    v_exp_f32 v111, v111
    v_exp_f32 v112, v112
    v_exp_f32 v113, v113
    v_exp_f32 v114, v114
    v_exp_f32 v115, v115
    v_pk_fma_f32 v[100:101], v[100:101], v[182:183], v[182:183] op_sel_hi:[1,0,0]
    v_pk_fma_f32 v[102:103], v[102:103], v[182:183], v[182:183] op_sel_hi:[1,0,0]
    v_pk_fma_f32 v[104:105], v[104:105], v[182:183], v[182:183] op_sel_hi:[1,0,0]
    v_pk_fma_f32 v[106:107], v[106:107], v[182:183], v[182:183] op_sel_hi:[1,0,0]
    v_pk_fma_f32 v[108:109], v[108:109], v[182:183], v[182:183] op_sel_hi:[1,0,0]
    v_pk_fma_f32 v[110:111], v[110:111], v[182:183], v[182:183] op_sel_hi:[1,0,0]
    v_pk_fma_f32 v[112:113], v[112:113], v[182:183], v[182:183] op_sel_hi:[1,0,0]
    v_pk_fma_f32 v[114:115], v[114:115], v[182:183], v[182:183] op_sel_hi:[1,0,0]
    v_rcp_f32 v100, v100
    v_rcp_f32 v101, v101
    v_rcp_f32 v102, v102
    v_rcp_f32 v103, v103
    v_rcp_f32 v104, v104
    v_rcp_f32 v105, v105
    v_rcp_f32 v106, v106
    v_rcp_f32 v107, v107
    v_rcp_f32 v108, v108
    v_rcp_f32 v109, v109
    v_rcp_f32 v110, v110
    v_rcp_f32 v111, v111
    v_rcp_f32 v112, v112
    v_rcp_f32 v113, v113
    v_rcp_f32 v114, v114
    v_rcp_f32 v115, v115
    v_pk_mul_f32 v[100:101], v[100:101], v[0:1]
    v_pk_mul_f32 v[102:103], v[102:103], v[2:3]
    v_pk_mul_f32 v[104:105], v[104:105], v[4:5]
    v_pk_mul_f32 v[106:107], v[106:107], v[6:7]
    v_pk_mul_f32 v[108:109], v[108:109], v[8:9]
    v_pk_mul_f32 v[110:111], v[110:111], v[10:11]
    v_pk_mul_f32 v[112:113], v[112:113], v[12:13]
    v_pk_mul_f32 v[114:115], v[114:115], v[14:15]
    v_cvt_pk_bf16_f32 v116, v100, v101
    v_cvt_pk_bf16_f32 v117, v102, v103
    v_cvt_pk_bf16_f32 v118, v104, v105
    v_cvt_pk_bf16_f32 v119, v106, v107
    v_cvt_pk_bf16_f32 v120, v108, v109
    v_cvt_pk_bf16_f32 v121, v110, v111
    v_cvt_pk_bf16_f32 v122, v112, v113
    v_cvt_pk_bf16_f32 v123, v114, v115
    buffer_store_dwordx4 v[116:119], v180, s[40:43], s75 offen offset:0 sc1
    buffer_store_dwordx4 v[120:123], v180, s[40:43], s75 offen offset:1024 sc1
    s_add_u32 s75, s75, s0
    s_nop 0
    v_pk_mul_f32 v[100:101], v[16:17], v[16:17]
    v_pk_mul_f32 v[102:103], v[18:19], v[18:19]
    v_pk_mul_f32 v[104:105], v[20:21], v[20:21]
    v_pk_mul_f32 v[106:107], v[22:23], v[22:23]
    v_pk_mul_f32 v[108:109], v[24:25], v[24:25]
    v_pk_mul_f32 v[110:111], v[26:27], v[26:27]
    v_pk_mul_f32 v[112:113], v[28:29], v[28:29]
    v_pk_mul_f32 v[114:115], v[30:31], v[30:31]
    v_pk_fma_f32 v[100:101], v[100:101], s[68:69], v[196:197] op_sel_hi:[1,1,0]
    v_pk_fma_f32 v[102:103], v[102:103], s[68:69], v[196:197] op_sel_hi:[1,1,0]
    v_pk_fma_f32 v[104:105], v[104:105], s[68:69], v[196:197] op_sel_hi:[1,1,0]
    v_pk_fma_f32 v[106:107], v[106:107], s[68:69], v[196:197] op_sel_hi:[1,1,0]
    v_pk_fma_f32 v[108:109], v[108:109], s[68:69], v[196:197] op_sel_hi:[1,1,0]
    v_pk_fma_f32 v[110:111], v[110:111], s[68:69], v[196:197] op_sel_hi:[1,1,0]
    v_pk_fma_f32 v[112:113], v[112:113], s[68:69], v[196:197] op_sel_hi:[1,1,0]
    v_pk_fma_f32 v[114:115], v[114:115], s[68:69], v[196:197] op_sel_hi:[1,1,0]
    v_pk_mul_f32 v[100:101], v[100:101], v[16:17]
    v_pk_mul_f32 v[102:103], v[102:103], v[18:19]
    v_pk_mul_f32 v[104:105], v[104:105], v[20:21]
    v_pk_mul_f32 v[106:107], v[106:107], v[22:23]
    v_pk_mul_f32 v[108:109], v[108:109], v[24:25]
    v_pk_mul_f32 v[110:111], v[110:111], v[26:27]
    v_pk_mul_f32 v[112:113], v[112:113], v[28:29]
    v_pk_mul_f32 v[114:115], v[114:115], v[30:31]
    v_exp_f32 v100, v100
    v_exp_f32 v101, v101
    v_exp_f32 v102, v102
    v_exp_f32 v103, v103
    v_exp_f32 v104, v104
    v_exp_f32 v105, v105
    v_exp_f32 v106, v106
    v_exp_f32 v107, v107
    v_exp_f32 v108, v108
    v_exp_f32 v109, v109
    v_exp_f32 v110, v110
    v_exp_f32 v111, v111
    v_exp_f32 v112, v112
    v_exp_f32 v113, v113
    v_exp_f32 v114, v114
    v_exp_f32 v115, v115
    v_pk_fma_f32 v[100:101], v[100:101], v[182:183], v[182:183] op_sel_hi:[1,0,0]
    v_pk_fma_f32 v[102:103], v[102:103], v[182:183], v[182:183] op_sel_hi:[1,0,0]
    v_pk_fma_f32 v[104:105], v[104:105], v[182:183], v[182:183] op_sel_hi:[1,0,0]
    v_pk_fma_f32 v[106:107], v[106:107], v[182:183], v[182:183] op_sel_hi:[1,0,0]
    v_pk_fma_f32 v[108:109], v[108:109], v[182:183], v[182:183] op_sel_hi:[1,0,0]
    v_pk_fma_f32 v[110:111], v[110:111], v[182:183], v[182:183] op_sel_hi:[1,0,0]
    v_pk_fma_f32 v[112:113], v[112:113], v[182:183], v[182:183] op_sel_hi:[1,0,0]
    v_pk_fma_f32 v[114:115], v[114:115], v[182:183], v[182:183] op_sel_hi:[1,0,0]
    v_rcp_f32 v100, v100
    v_rcp_f32 v101, v101
    v_rcp_f32 v102, v102
    v_rcp_f32 v103, v103
    v_rcp_f32 v104, v104
    v_rcp_f32 v105, v105
    v_rcp_f32 v106, v106
    v_rcp_f32 v107, v107
    v_rcp_f32 v108, v108
    v_rcp_f32 v109, v109
    v_rcp_f32 v110, v110
    v_rcp_f32 v111, v111
    v_rcp_f32 v112, v112
    v_rcp_f32 v113, v113
    v_rcp_f32 v114, v114
    v_rcp_f32 v115, v115
    v_pk_mul_f32 v[100:101], v[100:101], v[16:17]
    v_pk_mul_f32 v[102:103], v[102:103], v[18:19]
    v_pk_mul_f32 v[104:105], v[104:105], v[20:21]
    v_pk_mul_f32 v[106:107], v[106:107], v[22:23]
    v_pk_mul_f32 v[108:109], v[108:109], v[24:25]
    v_pk_mul_f32 v[110:111], v[110:111], v[26:27]
    v_pk_mul_f32 v[112:113], v[112:113], v[28:29]
    v_pk_mul_f32 v[114:115], v[114:115], v[30:31]
    v_cvt_pk_bf16_f32 v124, v100, v101
    v_cvt_pk_bf16_f32 v125, v102, v103
    v_cvt_pk_bf16_f32 v126, v104, v105
    v_cvt_pk_bf16_f32 v127, v106, v107
    v_cvt_pk_bf16_f32 v128, v108, v109
    v_cvt_pk_bf16_f32 v129, v110, v111
    v_cvt_pk_bf16_f32 v130, v112, v113
    v_cvt_pk_bf16_f32 v131, v114, v115
    buffer_store_dwordx4 v[124:127], v180, s[40:43], s75 offen offset:0 sc1
    buffer_store_dwordx4 v[128:131], v180, s[40:43], s75 offen offset:1024 sc1
    s_add_u32 s75, s75, s0
    s_nop 0
    v_pk_mul_f32 v[100:101], v[32:33], v[32:33]
    v_pk_mul_f32 v[102:103], v[34:35], v[34:35]
    v_pk_mul_f32 v[104:105], v[36:37], v[36:37]
    v_pk_mul_f32 v[106:107], v[38:39], v[38:39]
    v_pk_mul_f32 v[108:109], v[40:41], v[40:41]
    v_pk_mul_f32 v[110:111], v[42:43], v[42:43]
    v_pk_mul_f32 v[112:113], v[44:45], v[44:45]
    v_pk_mul_f32 v[114:115], v[46:47], v[46:47]
    v_pk_fma_f32 v[100:101], v[100:101], s[68:69], v[196:197] op_sel_hi:[1,1,0]
    v_pk_fma_f32 v[102:103], v[102:103], s[68:69], v[196:197] op_sel_hi:[1,1,0]
    v_pk_fma_f32 v[104:105], v[104:105], s[68:69], v[196:197] op_sel_hi:[1,1,0]
    v_pk_fma_f32 v[106:107], v[106:107], s[68:69], v[196:197] op_sel_hi:[1,1,0]
    v_pk_fma_f32 v[108:109], v[108:109], s[68:69], v[196:197] op_sel_hi:[1,1,0]
    v_pk_fma_f32 v[110:111], v[110:111], s[68:69], v[196:197] op_sel_hi:[1,1,0]
    v_pk_fma_f32 v[112:113], v[112:113], s[68:69], v[196:197] op_sel_hi:[1,1,0]
    v_pk_fma_f32 v[114:115], v[114:115], s[68:69], v[196:197] op_sel_hi:[1,1,0]
    v_pk_mul_f32 v[100:101], v[100:101], v[32:33]
    v_pk_mul_f32 v[102:103], v[102:103], v[34:35]
    v_pk_mul_f32 v[104:105], v[104:105], v[36:37]
    v_pk_mul_f32 v[106:107], v[106:107], v[38:39]
    v_pk_mul_f32 v[108:109], v[108:109], v[40:41]
    v_pk_mul_f32 v[110:111], v[110:111], v[42:43]
    v_pk_mul_f32 v[112:113], v[112:113], v[44:45]
    v_pk_mul_f32 v[114:115], v[114:115], v[46:47]
    v_exp_f32 v100, v100
    v_exp_f32 v101, v101
    v_exp_f32 v102, v102
    v_exp_f32 v103, v103
    v_exp_f32 v104, v104
    v_exp_f32 v105, v105
    v_exp_f32 v106, v106
    v_exp_f32 v107, v107
    v_exp_f32 v108, v108
    v_exp_f32 v109, v109
    v_exp_f32 v110, v110
    v_exp_f32 v111, v111
    v_exp_f32 v112, v112
    v_exp_f32 v113, v113
    v_exp_f32 v114, v114
    v_exp_f32 v115, v115
    v_pk_fma_f32 v[100:101], v[100:101], v[182:183], v[182:183] op_sel_hi:[1,0,0]
    v_pk_fma_f32 v[102:103], v[102:103], v[182:183], v[182:183] op_sel_hi:[1,0,0]
    v_pk_fma_f32 v[104:105], v[104:105], v[182:183], v[182:183] op_sel_hi:[1,0,0]
    v_pk_fma_f32 v[106:107], v[106:107], v[182:183], v[182:183] op_sel_hi:[1,0,0]
    v_pk_fma_f32 v[108:109], v[108:109], v[182:183], v[182:183] op_sel_hi:[1,0,0]
    v_pk_fma_f32 v[110:111], v[110:111], v[182:183], v[182:183] op_sel_hi:[1,0,0]
    v_pk_fma_f32 v[112:113], v[112:113], v[182:183], v[182:183] op_sel_hi:[1,0,0]
    v_pk_fma_f32 v[114:115], v[114:115], v[182:183], v[182:183] op_sel_hi:[1,0,0]
    v_rcp_f32 v100, v100
    v_rcp_f32 v101, v101
    v_rcp_f32 v102, v102
    v_rcp_f32 v103, v103
    v_rcp_f32 v104, v104
    v_rcp_f32 v105, v105
    v_rcp_f32 v106, v106
    v_rcp_f32 v107, v107
    v_rcp_f32 v108, v108
    v_rcp_f32 v109, v109
    v_rcp_f32 v110, v110
    v_rcp_f32 v111, v111
    v_rcp_f32 v112, v112
    v_rcp_f32 v113, v113
    v_rcp_f32 v114, v114
    v_rcp_f32 v115, v115
    v_pk_mul_f32 v[100:101], v[100:101], v[32:33]
    v_pk_mul_f32 v[102:103], v[102:103], v[34:35]
    v_pk_mul_f32 v[104:105], v[104:105], v[36:37]
    v_pk_mul_f32 v[106:107], v[106:107], v[38:39]
    v_pk_mul_f32 v[108:109], v[108:109], v[40:41]
    v_pk_mul_f32 v[110:111], v[110:111], v[42:43]
    v_pk_mul_f32 v[112:113], v[112:113], v[44:45]
    v_pk_mul_f32 v[114:115], v[114:115], v[46:47]
    v_cvt_pk_bf16_f32 v116, v100, v101
    v_cvt_pk_bf16_f32 v117, v102, v103
    v_cvt_pk_bf16_f32 v118, v104, v105
    v_cvt_pk_bf16_f32 v119, v106, v107
    v_cvt_pk_bf16_f32 v120, v108, v109
    v_cvt_pk_bf16_f32 v121, v110, v111
    v_cvt_pk_bf16_f32 v122, v112, v113
    v_cvt_pk_bf16_f32 v123, v114, v115
    buffer_store_dwordx4 v[116:119], v180, s[40:43], s75 offen offset:0 sc1
    buffer_store_dwordx4 v[120:123], v180, s[40:43], s75 offen offset:1024 sc1
    s_add_u32 s75, s75, s0
    s_nop 0
    v_pk_mul_f32 v[100:101], v[48:49], v[48:49]
    v_pk_mul_f32 v[102:103], v[50:51], v[50:51]
    v_pk_mul_f32 v[104:105], v[52:53], v[52:53]
    v_pk_mul_f32 v[106:107], v[54:55], v[54:55]
    v_pk_mul_f32 v[108:109], v[56:57], v[56:57]
    v_pk_mul_f32 v[110:111], v[58:59], v[58:59]
    v_pk_mul_f32 v[112:113], v[60:61], v[60:61]
    v_pk_mul_f32 v[114:115], v[62:63], v[62:63]
    v_pk_fma_f32 v[100:101], v[100:101], s[68:69], v[196:197] op_sel_hi:[1,1,0]
    v_pk_fma_f32 v[102:103], v[102:103], s[68:69], v[196:197] op_sel_hi:[1,1,0]
    v_pk_fma_f32 v[104:105], v[104:105], s[68:69], v[196:197] op_sel_hi:[1,1,0]
    v_pk_fma_f32 v[106:107], v[106:107], s[68:69], v[196:197] op_sel_hi:[1,1,0]
    v_pk_fma_f32 v[108:109], v[108:109], s[68:69], v[196:197] op_sel_hi:[1,1,0]
    v_pk_fma_f32 v[110:111], v[110:111], s[68:69], v[196:197] op_sel_hi:[1,1,0]
    v_pk_fma_f32 v[112:113], v[112:113], s[68:69], v[196:197] op_sel_hi:[1,1,0]
    v_pk_fma_f32 v[114:115], v[114:115], s[68:69], v[196:197] op_sel_hi:[1,1,0]
    v_pk_mul_f32 v[100:101], v[100:101], v[48:49]
    v_pk_mul_f32 v[102:103], v[102:103], v[50:51]
    v_pk_mul_f32 v[104:105], v[104:105], v[52:53]
    v_pk_mul_f32 v[106:107], v[106:107], v[54:55]
    v_pk_mul_f32 v[108:109], v[108:109], v[56:57]
    v_pk_mul_f32 v[110:111], v[110:111], v[58:59]
    v_pk_mul_f32 v[112:113], v[112:113], v[60:61]
    v_pk_mul_f32 v[114:115], v[114:115], v[62:63]
    v_exp_f32 v100, v100
    v_exp_f32 v101, v101
    v_exp_f32 v102, v102
    v_exp_f32 v103, v103
    v_exp_f32 v104, v104
    v_exp_f32 v105, v105
    v_exp_f32 v106, v106
    v_exp_f32 v107, v107
    v_exp_f32 v108, v108
    v_exp_f32 v109, v109
    v_exp_f32 v110, v110
    v_exp_f32 v111, v111
    v_exp_f32 v112, v112
    v_exp_f32 v113, v113
    v_exp_f32 v114, v114
    v_exp_f32 v115, v115
    v_pk_fma_f32 v[100:101], v[100:101], v[182:183], v[182:183] op_sel_hi:[1,0,0]
    v_pk_fma_f32 v[102:103], v[102:103], v[182:183], v[182:183] op_sel_hi:[1,0,0]
    v_pk_fma_f32 v[104:105], v[104:105], v[182:183], v[182:183] op_sel_hi:[1,0,0]
    v_pk_fma_f32 v[106:107], v[106:107], v[182:183], v[182:183] op_sel_hi:[1,0,0]
    v_pk_fma_f32 v[108:109], v[108:109], v[182:183], v[182:183] op_sel_hi:[1,0,0]
    v_pk_fma_f32 v[110:111], v[110:111], v[182:183], v[182:183] op_sel_hi:[1,0,0]
    v_pk_fma_f32 v[112:113], v[112:113], v[182:183], v[182:183] op_sel_hi:[1,0,0]
    v_pk_fma_f32 v[114:115], v[114:115], v[182:183], v[182:183] op_sel_hi:[1,0,0]
    v_rcp_f32 v100, v100
    v_rcp_f32 v101, v101
    v_rcp_f32 v102, v102
    v_rcp_f32 v103, v103
    v_rcp_f32 v104, v104
    v_rcp_f32 v105, v105
    v_rcp_f32 v106, v106
    v_rcp_f32 v107, v107
    v_rcp_f32 v108, v108
    v_rcp_f32 v109, v109
    v_rcp_f32 v110, v110
    v_rcp_f32 v111, v111
    v_rcp_f32 v112, v112
    v_rcp_f32 v113, v113
    v_rcp_f32 v114, v114
    v_rcp_f32 v115, v115
    v_pk_mul_f32 v[100:101], v[100:101], v[48:49]
    v_pk_mul_f32 v[102:103], v[102:103], v[50:51]
    v_pk_mul_f32 v[104:105], v[104:105], v[52:53]
    v_pk_mul_f32 v[106:107], v[106:107], v[54:55]
    v_pk_mul_f32 v[108:109], v[108:109], v[56:57]
    v_pk_mul_f32 v[110:111], v[110:111], v[58:59]
    v_pk_mul_f32 v[112:113], v[112:113], v[60:61]
    v_pk_mul_f32 v[114:115], v[114:115], v[62:63]
    v_cvt_pk_bf16_f32 v124, v100, v101
    v_cvt_pk_bf16_f32 v125, v102, v103
    v_cvt_pk_bf16_f32 v126, v104, v105
    v_cvt_pk_bf16_f32 v127, v106, v107
    v_cvt_pk_bf16_f32 v128, v108, v109
    v_cvt_pk_bf16_f32 v129, v110, v111
    v_cvt_pk_bf16_f32 v130, v112, v113
    v_cvt_pk_bf16_f32 v131, v114, v115
    buffer_store_dwordx4 v[124:127], v180, s[40:43], s75 offen offset:0 sc1
    buffer_store_dwordx4 v[128:131], v180, s[40:43], s75 offen offset:1024 sc1
    s_add_u32 s75, s75, s0
    s_nop 0
    v_pk_mul_f32 v[100:101], v[64:65], v[64:65]
    v_pk_mul_f32 v[102:103], v[66:67], v[66:67]
    v_pk_mul_f32 v[104:105], v[68:69], v[68:69]
    v_pk_mul_f32 v[106:107], v[70:71], v[70:71]
    v_pk_mul_f32 v[108:109], v[72:73], v[72:73]
    v_pk_mul_f32 v[110:111], v[74:75], v[74:75]
    v_pk_mul_f32 v[112:113], v[76:77], v[76:77]
    v_pk_mul_f32 v[114:115], v[78:79], v[78:79]
    v_pk_fma_f32 v[100:101], v[100:101], s[68:69], v[196:197] op_sel_hi:[1,1,0]
    v_pk_fma_f32 v[102:103], v[102:103], s[68:69], v[196:197] op_sel_hi:[1,1,0]
    v_pk_fma_f32 v[104:105], v[104:105], s[68:69], v[196:197] op_sel_hi:[1,1,0]
    v_pk_fma_f32 v[106:107], v[106:107], s[68:69], v[196:197] op_sel_hi:[1,1,0]
    v_pk_fma_f32 v[108:109], v[108:109], s[68:69], v[196:197] op_sel_hi:[1,1,0]
    v_pk_fma_f32 v[110:111], v[110:111], s[68:69], v[196:197] op_sel_hi:[1,1,0]
    v_pk_fma_f32 v[112:113], v[112:113], s[68:69], v[196:197] op_sel_hi:[1,1,0]
    v_pk_fma_f32 v[114:115], v[114:115], s[68:69], v[196:197] op_sel_hi:[1,1,0]
    v_pk_mul_f32 v[100:101], v[100:101], v[64:65]
    v_pk_mul_f32 v[102:103], v[102:103], v[66:67]
    v_pk_mul_f32 v[104:105], v[104:105], v[68:69]
    v_pk_mul_f32 v[106:107], v[106:107], v[70:71]
    v_pk_mul_f32 v[108:109], v[108:109], v[72:73]
    v_pk_mul_f32 v[110:111], v[110:111], v[74:75]
    v_pk_mul_f32 v[112:113], v[112:113], v[76:77]
    v_pk_mul_f32 v[114:115], v[114:115], v[78:79]
    v_exp_f32 v100, v100
    v_exp_f32 v101, v101
    v_exp_f32 v102, v102
    v_exp_f32 v103, v103
    v_exp_f32 v104, v104
    v_exp_f32 v105, v105
    v_exp_f32 v106, v106
    v_exp_f32 v107, v107
    v_exp_f32 v108, v108
    v_exp_f32 v109, v109
    v_exp_f32 v110, v110
    v_exp_f32 v111, v111
    v_exp_f32 v112, v112
    v_exp_f32 v113, v113
    v_exp_f32 v114, v114
    v_exp_f32 v115, v115
    v_pk_fma_f32 v[100:101], v[100:101], v[182:183], v[182:183] op_sel_hi:[1,0,0]
    v_pk_fma_f32 v[102:103], v[102:103], v[182:183], v[182:183] op_sel_hi:[1,0,0]
    v_pk_fma_f32 v[104:105], v[104:105], v[182:183], v[182:183] op_sel_hi:[1,0,0]
    v_pk_fma_f32 v[106:107], v[106:107], v[182:183], v[182:183] op_sel_hi:[1,0,0]
    v_pk_fma_f32 v[108:109], v[108:109], v[182:183], v[182:183] op_sel_hi:[1,0,0]
    v_pk_fma_f32 v[110:111], v[110:111], v[182:183], v[182:183] op_sel_hi:[1,0,0]
    v_pk_fma_f32 v[112:113], v[112:113], v[182:183], v[182:183] op_sel_hi:[1,0,0]
    v_pk_fma_f32 v[114:115], v[114:115], v[182:183], v[182:183] op_sel_hi:[1,0,0]
    v_rcp_f32 v100, v100
    v_rcp_f32 v101, v101
    v_rcp_f32 v102, v102
    v_rcp_f32 v103, v103
    v_rcp_f32 v104, v104
    v_rcp_f32 v105, v105
    v_rcp_f32 v106, v106
    v_rcp_f32 v107, v107
    v_rcp_f32 v108, v108
    v_rcp_f32 v109, v109
    v_rcp_f32 v110, v110
    v_rcp_f32 v111, v111
    v_rcp_f32 v112, v112
    v_rcp_f32 v113, v113
    v_rcp_f32 v114, v114
    v_rcp_f32 v115, v115
    v_pk_mul_f32 v[100:101], v[100:101], v[64:65]
    v_pk_mul_f32 v[102:103], v[102:103], v[66:67]
    v_pk_mul_f32 v[104:105], v[104:105], v[68:69]
    v_pk_mul_f32 v[106:107], v[106:107], v[70:71]
    v_pk_mul_f32 v[108:109], v[108:109], v[72:73]
    v_pk_mul_f32 v[110:111], v[110:111], v[74:75]
    v_pk_mul_f32 v[112:113], v[112:113], v[76:77]
    v_pk_mul_f32 v[114:115], v[114:115], v[78:79]
    v_cvt_pk_bf16_f32 v116, v100, v101
    v_cvt_pk_bf16_f32 v117, v102, v103
    v_cvt_pk_bf16_f32 v118, v104, v105
    v_cvt_pk_bf16_f32 v119, v106, v107
    v_cvt_pk_bf16_f32 v120, v108, v109
    v_cvt_pk_bf16_f32 v121, v110, v111
    v_cvt_pk_bf16_f32 v122, v112, v113
    v_cvt_pk_bf16_f32 v123, v114, v115
    s_waitcnt vmcnt(2)
    buffer_store_dword v184, v226, s[40:43], s73 offen sc1
    buffer_store_dwordx4 v[116:119], v180, s[40:43], s75 offen offset:0 sc1
    buffer_store_dwordx4 v[120:123], v180, s[40:43], s75 offen offset:1024 sc1
    s_add_u32 s75, s75, s0
    s_cmp_eq_u32 s54, 6
    s_cbranch_scc1 L_biasblk
    s_cmp_eq_u32 s55, 0
    s_cselect_b32 s75, s75, 1073741824
    s_cbranch_scc0 L_blk5st
    s_nop 0
    v_pk_mul_f32 v[100:101], v[80:81], v[80:81]
    v_pk_mul_f32 v[102:103], v[82:83], v[82:83]
    v_pk_mul_f32 v[104:105], v[84:85], v[84:85]
    v_pk_mul_f32 v[106:107], v[86:87], v[86:87]
    v_pk_mul_f32 v[108:109], v[88:89], v[88:89]
    v_pk_mul_f32 v[110:111], v[90:91], v[90:91]
    v_pk_mul_f32 v[112:113], v[92:93], v[92:93]
    v_pk_mul_f32 v[114:115], v[94:95], v[94:95]
    v_pk_fma_f32 v[100:101], v[100:101], s[68:69], v[196:197] op_sel_hi:[1,1,0]
    v_pk_fma_f32 v[102:103], v[102:103], s[68:69], v[196:197] op_sel_hi:[1,1,0]
    v_pk_fma_f32 v[104:105], v[104:105], s[68:69], v[196:197] op_sel_hi:[1,1,0]
    v_pk_fma_f32 v[106:107], v[106:107], s[68:69], v[196:197] op_sel_hi:[1,1,0]
    v_pk_fma_f32 v[108:109], v[108:109], s[68:69], v[196:197] op_sel_hi:[1,1,0]
    v_pk_fma_f32 v[110:111], v[110:111], s[68:69], v[196:197] op_sel_hi:[1,1,0]
    v_pk_fma_f32 v[112:113], v[112:113], s[68:69], v[196:197] op_sel_hi:[1,1,0]
    v_pk_fma_f32 v[114:115], v[114:115], s[68:69], v[196:197] op_sel_hi:[1,1,0]
    v_pk_mul_f32 v[100:101], v[100:101], v[80:81]
    v_pk_mul_f32 v[102:103], v[102:103], v[82:83]
    v_pk_mul_f32 v[104:105], v[104:105], v[84:85]
    v_pk_mul_f32 v[106:107], v[106:107], v[86:87]
    v_pk_mul_f32 v[108:109], v[108:109], v[88:89]
    v_pk_mul_f32 v[110:111], v[110:111], v[90:91]
    v_pk_mul_f32 v[112:113], v[112:113], v[92:93]
    v_pk_mul_f32 v[114:115], v[114:115], v[94:95]
    v_exp_f32 v100, v100
    v_exp_f32 v101, v101
    v_exp_f32 v102, v102
    v_exp_f32 v103, v103
    v_exp_f32 v104, v104
    v_exp_f32 v105, v105
    v_exp_f32 v106, v106
    v_exp_f32 v107, v107
    v_exp_f32 v108, v108
    v_exp_f32 v109, v109
    v_exp_f32 v110, v110
    v_exp_f32 v111, v111
    v_exp_f32 v112, v112
    v_exp_f32 v113, v113
    v_exp_f32 v114, v114
    v_exp_f32 v115, v115
    v_pk_fma_f32 v[100:101], v[100:101], v[182:183], v[182:183] op_sel_hi:[1,0,0]
    v_pk_fma_f32 v[102:103], v[102:103], v[182:183], v[182:183] op_sel_hi:[1,0,0]
    v_pk_fma_f32 v[104:105], v[104:105], v[182:183], v[182:183] op_sel_hi:[1,0,0]
    v_pk_fma_f32 v[106:107], v[106:107], v[182:183], v[182:183] op_sel_hi:[1,0,0]
    v_pk_fma_f32 v[108:109], v[108:109], v[182:183], v[182:183] op_sel_hi:[1,0,0]
    v_pk_fma_f32 v[110:111], v[110:111], v[182:183], v[182:183] op_sel_hi:[1,0,0]
    v_pk_fma_f32 v[112:113], v[112:113], v[182:183], v[182:183] op_sel_hi:[1,0,0]
    v_pk_fma_f32 v[114:115], v[114:115], v[182:183], v[182:183] op_sel_hi:[1,0,0]
    v_rcp_f32 v100, v100
    v_rcp_f32 v101, v101
    v_rcp_f32 v102, v102
    v_rcp_f32 v103, v103
    v_rcp_f32 v104, v104
    v_rcp_f32 v105, v105
    v_rcp_f32 v106, v106
    v_rcp_f32 v107, v107
    v_rcp_f32 v108, v108
    v_rcp_f32 v109, v109
    v_rcp_f32 v110, v110
    v_rcp_f32 v111, v111
    v_rcp_f32 v112, v112
    v_rcp_f32 v113, v113
    v_rcp_f32 v114, v114
    v_rcp_f32 v115, v115
    v_pk_mul_f32 v[100:101], v[100:101], v[80:81]
    v_pk_mul_f32 v[102:103], v[102:103], v[82:83]
    v_pk_mul_f32 v[104:105], v[104:105], v[84:85]
    v_pk_mul_f32 v[106:107], v[106:107], v[86:87]
    v_pk_mul_f32 v[108:109], v[108:109], v[88:89]
    v_pk_mul_f32 v[110:111], v[110:111], v[90:91]
    v_pk_mul_f32 v[112:113], v[112:113], v[92:93]
    v_pk_mul_f32 v[114:115], v[114:115], v[94:95]
    v_cvt_pk_bf16_f32 v124, v100, v101
    v_cvt_pk_bf16_f32 v125, v102, v103
    v_cvt_pk_bf16_f32 v126, v104, v105
    v_cvt_pk_bf16_f32 v127, v106, v107
    v_cvt_pk_bf16_f32 v128, v108, v109
    v_cvt_pk_bf16_f32 v129, v110, v111
    v_cvt_pk_bf16_f32 v130, v112, v113
    v_cvt_pk_bf16_f32 v131, v114, v115
L_blk5st:
    buffer_store_dwordx4 v[124:127], v180, s[40:43], s75 offen offset:0 sc1
    buffer_store_dwordx4 v[128:131], v180, s[40:43], s75 offen offset:1024 sc1
    s_add_u32 s48, s59, 245760
    s_add_u32 s49, s59, 245760
    s_add_u32 m0, s72, 81920
    s_nop 0
    buffer_load_dwordx4 v164, s[32:35], s48 offen offset:0 lds
    buffer_load_dwordx4 v165, s[32:35], s48 offen offset:1024 lds
    buffer_load_dwordx4 v166, s[32:35], s48 offen offset:2048 lds
    buffer_load_dwordx4 v167, s[32:35], s48 offen offset:3072 lds
    s_add_u32 m0, m0, 4096
    s_nop 0
    ds_read_b64_tr_b16 a[0:1], v218 offset:0
    ds_read_b64_tr_b16 a[2:3], v218 offset:1024
    ds_read_b64_tr_b16 a[4:5], v219 offset:0
    ds_read_b64_tr_b16 a[6:7], v219 offset:1024
    ds_read_b64_tr_b16 a[8:9], v218 offset:2048
    ds_read_b64_tr_b16 a[10:11], v218 offset:3072
    ds_read_b64_tr_b16 a[12:13], v219 offset:2048
    ds_read_b64_tr_b16 a[14:15], v219 offset:3072
    ds_read_b64_tr_b16 a[16:17], v218 offset:4096
    ds_read_b64_tr_b16 a[18:19], v218 offset:5120
    ds_read_b64_tr_b16 a[20:21], v219 offset:4096
    ds_read_b64_tr_b16 a[22:23], v219 offset:5120
    ds_read_b64_tr_b16 a[24:25], v218 offset:6144
    ds_read_b64_tr_b16 a[26:27], v218 offset:7168
    ds_read_b64_tr_b16 a[28:29], v219 offset:6144
    ds_read_b64_tr_b16 a[30:31], v219 offset:7168
    ds_read_b64_tr_b16 a[32:33], v218 offset:8192
    ds_read_b64_tr_b16 a[34:35], v218 offset:9216
    ds_read_b64_tr_b16 a[36:37], v219 offset:8192
    ds_read_b64_tr_b16 a[38:39], v219 offset:9216
    buffer_load_dwordx4 v168, s[32:35], s49 offen offset:0 lds
    buffer_load_dwordx4 v169, s[32:35], s49 offen offset:1024 lds
    buffer_load_dwordx4 v170, s[32:35], s49 offen offset:2048 lds
    buffer_load_dwordx4 v171, s[32:35], s49 offen offset:3072 lds
    s_add_u32 m0, m0, 4096
    s_nop 0
    buffer_load_dwordx4 v172, s[32:35], s49 offen offset:0 lds
    buffer_load_dwordx4 v173, s[32:35], s49 offen offset:1024 lds
    ds_read_b64_tr_b16 a[40:41], v220 offset:0
    ds_read_b64_tr_b16 a[42:43], v220 offset:1024
    ds_read_b64_tr_b16 a[44:45], v221 offset:0
    ds_read_b64_tr_b16 a[46:47], v221 offset:1024
    ds_read_b64_tr_b16 a[48:49], v220 offset:2048
    ds_read_b64_tr_b16 a[50:51], v220 offset:3072
    ds_read_b64_tr_b16 a[52:53], v221 offset:2048
    ds_read_b64_tr_b16 a[54:55], v221 offset:3072
    ds_read_b64_tr_b16 a[56:57], v220 offset:4096
    ds_read_b64_tr_b16 a[58:59], v220 offset:5120
    ds_read_b64_tr_b16 a[60:61], v221 offset:4096
    ds_read_b64_tr_b16 a[62:63], v221 offset:5120
    ds_read_b64_tr_b16 a[64:65], v220 offset:6144
    ds_read_b64_tr_b16 a[66:67], v220 offset:7168
    ds_read_b64_tr_b16 a[68:69], v221 offset:6144
    ds_read_b64_tr_b16 a[70:71], v221 offset:7168
    ds_read_b64_tr_b16 a[72:73], v220 offset:8192
    ds_read_b64_tr_b16 a[74:75], v220 offset:9216
    ds_read_b64_tr_b16 a[76:77], v221 offset:8192
    ds_read_b64_tr_b16 a[78:79], v221 offset:9216
    s_waitcnt vmcnt(10)
    buffer_store_dword v184, v226, s[40:43], s76 offen sc1
    s_mov_b32 s73, 1073741824
    s_waitcnt lgkmcnt(0)
    s_add_u32 s48, s59, 327680
    s_lshl_b32 s49, s52, 17
    s_add_u32 m0, s72, 0
    s_nop 0
    buffer_load_dwordx4 v164, s[32:35], s48 offen offset:0 lds
    buffer_load_dwordx4 v165, s[32:35], s48 offen offset:1024 lds
    buffer_load_dwordx4 v166, s[32:35], s48 offen offset:2048 lds
    buffer_load_dwordx4 v167, s[32:35], s48 offen offset:3072 lds
    s_add_u32 m0, m0, 4096
    s_nop 0
    buffer_load_dwordx4 v168, s[36:39], s49 offen offset:0 lds
    buffer_load_dwordx4 v169, s[36:39], s49 offen offset:1024 lds
    buffer_load_dwordx4 v170, s[36:39], s49 offen offset:2048 lds
    buffer_load_dwordx4 v171, s[36:39], s49 offen offset:3072 lds
    s_add_u32 m0, m0, 4096
    s_nop 0
    buffer_load_dwordx4 v172, s[36:39], s49 offen offset:0 lds
    buffer_load_dwordx4 v173, s[36:39], s49 offen offset:1024 lds
    s_add_u32 s64, s74, 4096
    buffer_load_dword v186, v225, s[40:43], s64 offen sc1
    s_mov_b32 s48, s60
    s_add_u32 s49, s59, 163840
    s_add_u32 m0, s72, 40960
    s_nop 0
    buffer_load_dwordx4 v164, s[32:35], s48 offen offset:0 lds
    buffer_load_dwordx4 v165, s[32:35], s48 offen offset:1024 lds
    buffer_load_dwordx4 v166, s[32:35], s48 offen offset:2048 lds
    buffer_load_dwordx4 v167, s[32:35], s48 offen offset:3072 lds
    s_add_u32 m0, m0, 4096
    s_nop 0
    buffer_load_dwordx4 v168, s[32:35], s49 offen offset:0 lds
    buffer_load_dwordx4 v169, s[32:35], s49 offen offset:1024 lds
    buffer_load_dwordx4 v170, s[32:35], s49 offen offset:2048 lds
    buffer_load_dwordx4 v171, s[32:35], s49 offen offset:3072 lds
    s_add_u32 m0, m0, 4096
    s_nop 0
    buffer_load_dwordx4 v172, s[32:35], s49 offen offset:0 lds
    buffer_load_dwordx4 v173, s[32:35], s49 offen offset:1024 lds
    s_add_u32 s66, s72, 81920
    s_waitcnt vmcnt(10)
    v_cmp_ne_u32 vcc, s65, v186
    s_cbranch_vccnz L_h1f_r
L_h1f_ok:
    s_mul_i32 s61, s52, 22528
    buffer_load_dwordx4 v[0:3], v222, s[40:43], s61 offen offset:0 sc1
    buffer_load_dwordx4 v[4:7], v223, s[40:43], s61 offen offset:0 sc1
    buffer_load_dwordx4 v[8:11], v222, s[40:43], s61 offen offset:1024 sc1
    buffer_load_dwordx4 v[12:15], v223, s[40:43], s61 offen offset:1024 sc1
    buffer_load_dwordx4 v[16:19], v222, s[40:43], s61 offen offset:2048 sc1
    buffer_load_dwordx4 v[20:23], v223, s[40:43], s61 offen offset:2048 sc1
    buffer_load_dwordx4 v[24:27], v222, s[40:43], s61 offen offset:3072 sc1
    buffer_load_dwordx4 v[28:31], v223, s[40:43], s61 offen offset:3072 sc1
    s_add_u32 s61, s61, 4096
    buffer_load_dwordx4 v[80:83], v222, s[40:43], s61 offen offset:0 sc1
    buffer_load_dwordx4 v[84:87], v223, s[40:43], s61 offen offset:0 sc1
    buffer_load_dwordx4 v[88:91], v222, s[40:43], s61 offen offset:1024 sc1
    buffer_load_dwordx4 v[92:95], v223, s[40:43], s61 offen offset:1024 sc1
    s_branch L_s0
L_att:
    s_mul_i32 s72, s52, 10240
    s_mov_b32 s48, 128
    s_mov_b32 s49, s50
    v_lshlrev_b32 v180, 4, v179
    v_and_b32 v233, 31, v179
    v_lshl_add_u32 v185, v1, 10, v6
    v_bfe_u32 v2, v179, 1, 3
    v_xor_b32 v2, v2, v232
    v_lshlrev_b32 v2, 4, v2
    v_lshl_add_u32 v2, v233, 7, v2
    v_add_u32_e64 v174, s66, v2
    v_bfe_u32 v1, v179, 2, 2
    v_bfe_u32 v2, v179, 4, 1
    v_lshrrev_b32 v4, 1, v4
    v_lshl_add_u32 v4, v2, 5, v4
    v_lshl_add_u32 v216, v1, 6, v4
    v_mad_u32_u24 v175, s61, v232, v216
    v_mov_b32 v181, 0
    s_cmp_lt_u32 s52, 2
    s_cbranch_scc1 L_nowphi
    s_mov_b32 s44, s8
    s_mov_b32 s45, s9
    s_mov_b32 s46, 16384
    s_mov_b32 s47, 0x20000
    s_lshl_b32 s61, s54, 1
    s_add_u32 s61, s61, s52
    s_sub_u32 s61, s61, 2
    s_lshl_b32 s62, s52, 10
    s_add_u32 m0, s62, 155648
    s_lshl_b32 s61, s61, 10
    buffer_load_dwordx4 v180, s[44:47], s61 offen lds
L_nowphi:
    v_add_u32 v176, 32768, v174
    v_add_u32 v177, 32768, v175
    s_add_u32 m0, s66, 65536
    s_mul_i32 s61, s52, 147456
    s_sub_u32 s61, s61, 1024
    v_add_u32 v199, s61, v168
    s_lshr_b32 s57, s2, 5
    s_and_b32 s56, s2, 7
    buffer_load_dwordx4 v164, s[32:35], s48 offen offset:0 lds
    s_lshl_b32 s56, s56, 2
    s_bfe_u32 s62, s2, 0x20003
    s_add_u32 s56, s56, s62
    v_min_u32 v186, 58, v179
    s_and_b32 s62, s2, 63
    buffer_load_dwordx4 v165, s[32:35], s48 offen offset:1024 lds
    s_lshl_b32 s61, s62, 2
    s_add_u32 s61, s61, s52
    s_mul_i32 s61, s61, 59
    v_add_lshl_u32 v237, s61, v186, 7
    s_lshr_b32 s61, s2, 3
    buffer_load_dwordx4 v166, s[32:35], s48 offen offset:2048 lds
    s_mul_i32 s61, s61, 59
    v_add_lshl_u32 v236, s61, v186, 10
    v_add_u32 v236, 384, v236
    s_mov_b32 s40, s28
    s_mov_b32 s41, s29
    buffer_load_dwordx4 v167, s[32:35], s48 offen offset:3072 lds
    s_mov_b32 s42, 268435456
    s_mov_b32 s43, 0x20000
    v_lshl_add_u32 v185, s57, 7, v185
    s_and_b32 s61, s51, 1
    s_lshl_b32 s61, s61, 3
    s_add_u32 m0, m0, 4096
    s_add_u32 s61, s61, s54
    s_lshl_b32 s62, s53, 4
    s_add_u32 s62, s62, s61
    s_lshl_b32 s62, s62, 2
    s_add_u32 s62, s62, s52
    buffer_load_dwordx4 v168, s[36:39], s49 offen offset:0 lds
    s_lshl_b32 s62, s62, 7
    s_add_u32 s73, s62, 9437184
    s_lshl_b32 s64, s53, 2
    s_add_u32 s64, s64, s52
    s_mul_i32 s75, s64, 122880
    buffer_load_dwordx4 v168, s[36:39], s49 offen offset:1024 lds
    s_lshl_b32 s1, s64, 8
    s_add_u32 s1, s1, 9961472
    v_lshlrev_b32 v254, 3, v233
    v_lshl_add_u32 v198, v232, 10, v216
    v_lshl_add_u32 v216, v232, 8, v216
    buffer_load_dwordx4 v170, s[36:39], s49 offen offset:2048 lds
    s_and_b32 s61, s52, 1
    s_lshl_b32 s61, s61, 9
    s_add_u32 s61, s61, s72
    v_add_u32_e64 v186, s61, v216
    v_add_u32 v216, 114688, v186
    buffer_load_dwordx4 v170, s[36:39], s49 offen offset:3072 lds
    v_xor_b32 v217, 512, v216
    v_add_u32 v218, 65536, v186
    v_xor_b32 v219, 512, v218
    v_add_u32 v220, 0, v186
    v_xor_b32 v221, 512, v220
    s_mov_b32 s48, 256
    s_add_u32 s49, s49, s50
    s_waitcnt lgkmcnt(0)
    s_waitcnt vmcnt(8)
    s_barrier
    ds_read_b128 a[120:123], v176
    ds_read_b64_tr_b16 v[100:101], v177 offset:4096
    ds_read_b64_tr_b16 v[102:103], v177 offset:4352
    s_add_u32 m0, s66, 0
    ds_read_b64_tr_b16 v[104:105], v177 offset:4608
    ds_read_b64_tr_b16 v[106:107], v177 offset:4864
    ds_read_b64_tr_b16 v[108:109], v177 offset:5120
    buffer_load_dwordx4 v164, s[32:35], s48 offen offset:0 lds
    ds_read_b64_tr_b16 v[110:111], v177 offset:5376
    ds_read_b64_tr_b16 v[112:113], v177 offset:5632
    ds_read_b64_tr_b16 v[114:115], v177 offset:5888
    v_xor_b32 v176, 32, v176
    buffer_load_dwordx4 v165, s[32:35], s48 offen offset:1024 lds
    s_waitcnt lgkmcnt(4)
    v_mfma_f32_32x32x16_bf16 v[32:47], v[100:103], a[120:123], 0
    ds_read_b128 a[124:127], v176
    ds_read_b64_tr_b16 v[132:133], v177 offset:12288
    ds_read_b64_tr_b16 v[134:135], v177 offset:12544
    buffer_load_dwordx4 v166, s[32:35], s48 offen offset:2048 lds
    s_mul_i32 s58, s52, 360448
    s_add_u32 s60, s58, 163840
    v_mfma_f32_32x32x16_bf16 v[48:63], v[104:107], a[120:123], 0
    ds_read_b64_tr_b16 v[136:137], v177 offset:12800
    ds_read_b64_tr_b16 v[138:139], v177 offset:13056
    ds_read_b64_tr_b16 v[140:141], v177 offset:13312
    s_waitcnt lgkmcnt(6)
    v_mfma_f32_32x32x16_bf16 v[64:79], v[108:111], a[120:123], 0
    ds_read_b64_tr_b16 v[142:143], v177 offset:13568
    ds_read_b64_tr_b16 v[144:145], v177 offset:13824
    ds_read_b64_tr_b16 v[146:147], v177 offset:14080
    v_xor_b32 v176, 96, v176
    v_mfma_f32_32x32x16_bf16 v[80:95], v[112:115], a[120:123], 0
    buffer_load_dwordx4 v167, s[32:35], s48 offen offset:3072 lds
    s_add_u32 m0, m0, 4096
    s_cmp_eq_u32 s52, 3
    s_cselect_b32 s60, 1073741824, s60
    s_cselect_b32 s61, 32768, 0
    s_waitcnt lgkmcnt(4)
    v_mfma_f32_32x32x16_bf16 v[32:47], v[132:135], a[124:127], v[32:47]
    ds_read_b128 a[128:131], v176
    ds_read_b64_tr_b16 v[100:101], v177 offset:20480
    ds_read_b64_tr_b16 v[102:103], v177 offset:20736
    buffer_load_dwordx4 v168, s[36:39], s49 offen offset:0 lds
    s_sub_u32 s59, s58, s61
    s_mov_b32 s70, 0x3fb8aa3b
    v_mfma_f32_32x32x16_bf16 v[48:63], v[136:139], a[124:127], v[48:63]
    ds_read_b64_tr_b16 v[104:105], v177 offset:20992
    ds_read_b64_tr_b16 v[106:107], v177 offset:21248
    ds_read_b64_tr_b16 v[108:109], v177 offset:21504
    s_waitcnt lgkmcnt(6)
    s_mov_b32 s71, s70
    v_and_b32 v193, 1, v179
    v_mfma_f32_32x32x16_bf16 v[64:79], v[140:143], a[124:127], v[64:79]
    ds_read_b64_tr_b16 v[110:111], v177 offset:21760
    ds_read_b64_tr_b16 v[112:113], v177 offset:22016
    ds_read_b64_tr_b16 v[114:115], v177 offset:22272
    v_xor_b32 v176, 32, v176
    v_bfe_u32 v192, v179, 1, 1
    v_lshl_add_u32 v186, v192, 2, v193
    v_mfma_f32_32x32x16_bf16 v[80:95], v[144:147], a[124:127], v[80:95]
    buffer_load_dwordx4 v168, s[36:39], s49 offen offset:1024 lds
    v_lshlrev_b32 v225, 7, v186
    v_bfe_u32 v187, v179, 2, 2
    v_bfe_u32 v188, v179, 4, 1
    v_lshl_add_u32 v187, v232, 2, v187
    s_waitcnt lgkmcnt(4)
    v_mfma_f32_32x32x16_bf16 v[32:47], v[100:103], a[128:131], v[32:47]
    ds_read_b128 a[132:135], v176
    ds_read_b64_tr_b16 v[132:133], v177 offset:28672
    ds_read_b64_tr_b16 v[134:135], v177 offset:28928
    ds_read_b64_tr_b16 v[136:137], v177 offset:29184
    buffer_load_dwordx4 v170, s[36:39], s49 offen offset:2048 lds
    v_lshl_add_u32 v190, v188, 1, v192
    v_mfma_f32_32x32x16_bf16 v[48:63], v[104:107], a[128:131], v[48:63]
    ds_read_b64_tr_b16 v[138:139], v177 offset:29440
    ds_read_b64_tr_b16 v[140:141], v177 offset:29696
    ds_read_b64_tr_b16 v[142:143], v177 offset:29952
    ds_read_b64_tr_b16 v[144:145], v177 offset:30208
    s_waitcnt lgkmcnt(8)
    v_lshlrev_b32 v190, 3, v190
    v_mfma_f32_32x32x16_bf16 v[64:79], v[108:111], a[128:131], v[64:79]
    ds_read_b64_tr_b16 v[146:147], v177 offset:30464
    buffer_load_dwordx4 v170, s[36:39], s49 offen offset:3072 lds
    v_lshl_add_u32 v190, v187, 5, v190
    v_add_u32 v196, 157696, v190
    ds_read_b64_tr_b16 v[200:201], v196 offset:0
    ds_read_b64_tr_b16 v[202:203], v196 offset:256
    v_mfma_f32_32x32x16_bf16 v[80:95], v[112:115], a[128:131], v[80:95]
    v_add_u32 v176, 65536, v174
    v_add_u32 v177, 65536, v175
    s_add_u32 s48, s48, 128
    s_add_u32 s49, s49, s50
    ds_read_b64_tr_b16 v[204:205], v196 offset:512
    s_waitcnt lgkmcnt(0)
    v_mfma_f32_32x32x16_bf16 v[32:47], v[132:135], a[132:135], v[32:47]
    s_waitcnt vmcnt(8)
    s_barrier
    ds_read_b128 a[136:139], v176
    ds_read_b64_tr_b16 v[100:101], v177 offset:4096
    ds_read_b64_tr_b16 v[102:103], v177 offset:4352
    s_add_u32 m0, s66, 32768
    v_mfma_f32_32x32x16_bf16 v[48:63], v[136:139], a[132:135], v[48:63]
    ds_read_b64_tr_b16 v[104:105], v177 offset:4608
    ds_read_b64_tr_b16 v[106:107], v177 offset:4864
    ds_read_b64_tr_b16 v[108:109], v177 offset:5120
    buffer_load_dwordx4 v164, s[32:35], s48 offen offset:0 lds
    ds_read_b64_tr_b16 v[206:207], v196 offset:768
    ds_read_b64_tr_b16 v[208:209], v196 offset:1024
    v_mfma_f32_32x32x16_bf16 v[64:79], v[140:143], a[132:135], v[64:79]
    ds_read_b64_tr_b16 v[110:111], v177 offset:5376
    ds_read_b64_tr_b16 v[112:113], v177 offset:5632
    ds_read_b64_tr_b16 v[114:115], v177 offset:5888
    v_xor_b32 v176, 32, v176
    ds_read_b64_tr_b16 v[210:211], v196 offset:1280
    ds_read_b64_tr_b16 v[212:213], v196 offset:1536
    v_mfma_f32_32x32x16_bf16 v[80:95], v[144:147], a[132:135], v[80:95]
    buffer_load_dwordx4 v165, s[32:35], s48 offen offset:1024 lds
    ds_read_b64_tr_b16 v[214:215], v196 offset:1792
    v_bfe_u32 v190, v179, 2, 1
    v_mul_u32_u24 v197, 0x8000, v190
    v_lshl_or_b32 v197, v197, 16, v197
    s_waitcnt lgkmcnt(4)
    v_mfma_f32_32x32x16_bf16 v[32:47], v[100:103], a[136:139], v[32:47]
    ds_read_b128 a[140:143], v176
    ds_read_b64_tr_b16 v[132:133], v177 offset:12288
    ds_read_b64_tr_b16 v[134:135], v177 offset:12544
    buffer_load_dwordx4 v166, s[32:35], s48 offen offset:2048 lds
    v_lshrrev_b32 v191, 1, v187
    v_lshlrev_b32 v187, 6, v187
    v_mfma_f32_32x32x16_bf16 v[48:63], v[104:107], a[136:139], v[48:63]
    ds_read_b64_tr_b16 v[136:137], v177 offset:12800
    ds_read_b64_tr_b16 v[138:139], v177 offset:13056
    ds_read_b64_tr_b16 v[140:141], v177 offset:13312
    s_waitcnt lgkmcnt(6)
    v_lshl_add_u32 v187, v192, 3, v187
    v_lshl_add_u32 v190, v193, 1, v188
    v_mfma_f32_32x32x16_bf16 v[64:79], v[108:111], a[136:139], v[64:79]
    ds_read_b64_tr_b16 v[142:143], v177 offset:13568
    ds_read_b64_tr_b16 v[144:145], v177 offset:13824
    ds_read_b64_tr_b16 v[146:147], v177 offset:14080
    v_xor_b32 v176, 96, v176
    v_xor_b32 v190, v190, v191
    v_lshl_add_u32 v190, v190, 4, v187
    v_mfma_f32_32x32x16_bf16 v[80:95], v[112:115], a[136:139], v[80:95]
    buffer_load_dwordx4 v167, s[32:35], s48 offen offset:3072 lds
    s_add_u32 m0, m0, 4096
    s_lshl_b32 s61, s52, 13
    s_add_u32 s61, s61, 65536
    v_add_u32 v238, s61, v190
    s_waitcnt lgkmcnt(4)
    v_mfma_f32_32x32x16_bf16 v[32:47], v[132:135], a[140:143], v[32:47]
    ds_read_b128 a[144:147], v176
    ds_read_b64_tr_b16 v[100:101], v177 offset:20480
    ds_read_b64_tr_b16 v[102:103], v177 offset:20736
    buffer_load_dwordx4 v168, s[36:39], s49 offen offset:0 lds
    s_and_b32 s61, s52, 1
    v_lshl_add_u32 v190, s61, 1, v193
    v_mfma_f32_32x32x16_bf16 v[48:63], v[136:139], a[140:143], v[48:63]
    ds_read_b64_tr_b16 v[104:105], v177 offset:20992
    ds_read_b64_tr_b16 v[106:107], v177 offset:21248
    ds_read_b64_tr_b16 v[108:109], v177 offset:21504
    s_waitcnt lgkmcnt(6)
    v_xor_b32 v190, v190, v191
    v_lshl_add_u32 v190, v190, 4, v187
    v_mfma_f32_32x32x16_bf16 v[64:79], v[140:143], a[140:143], v[64:79]
    ds_read_b64_tr_b16 v[110:111], v177 offset:21760
    ds_read_b64_tr_b16 v[112:113], v177 offset:22016
    ds_read_b64_tr_b16 v[114:115], v177 offset:22272
    v_xor_b32 v176, 32, v176
    s_lshr_b32 s61, s52, 1
    s_lshl_b32 s61, s61, 13
    v_mfma_f32_32x32x16_bf16 v[80:95], v[144:147], a[140:143], v[80:95]
    buffer_load_dwordx4 v168, s[36:39], s49 offen offset:1024 lds
    s_add_u32 s61, s61, 98304
    v_add_u32 v190, s61, v190
    v_cmp_eq_u32 vcc, 0, v188
    v_mov_b32 v191, 159744
    s_waitcnt lgkmcnt(4)
    v_mfma_f32_32x32x16_bf16 v[32:47], v[100:103], a[144:147], v[32:47]
    ds_read_b128 a[148:151], v176
    ds_read_b64_tr_b16 v[132:133], v177 offset:28672
    ds_read_b64_tr_b16 v[134:135], v177 offset:28928
    ds_read_b64_tr_b16 v[136:137], v177 offset:29184
    buffer_load_dwordx4 v170, s[36:39], s49 offen offset:2048 lds
    v_mov_b32 v187, 512
    v_mfma_f32_32x32x16_bf16 v[48:63], v[104:107], a[144:147], v[48:63]
    ds_read_b64_tr_b16 v[138:139], v177 offset:29440
    ds_read_b64_tr_b16 v[140:141], v177 offset:29696
    ds_read_b64_tr_b16 v[142:143], v177 offset:29952
    ds_read_b64_tr_b16 v[144:145], v177 offset:30208
    s_waitcnt lgkmcnt(8)
    v_cndmask_b32 v239, v191, v190, vcc
    v_mfma_f32_32x32x16_bf16 v[64:79], v[108:111], a[144:147], v[64:79]
    ds_read_b64_tr_b16 v[146:147], v177 offset:30464
    buffer_load_dwordx4 v170, s[36:39], s49 offen offset:3072 lds
    v_cndmask_b32 v240, 0, v187, vcc
    v_mov_b32 v194, 0x3f803f80
    v_mov_b32 v195, 0x3f803f80
    ds_write_b64 v191, v[194:195]
    v_mfma_f32_32x32x16_bf16 v[80:95], v[112:115], a[144:147], v[80:95]
    v_add_u32 v176, 0, v174
    v_add_u32 v177, 0, v175
    s_add_u32 s48, s48, 128
    s_add_u32 s49, s49, s50
    s_lshl_b32 s61, s52, 11
    s_waitcnt lgkmcnt(0)
    v_mfma_f32_32x32x16_bf16 v[32:47], v[132:135], a[148:151], v[32:47]
    s_waitcnt vmcnt(8)
    s_barrier
    ds_read_b128 a[152:155], v176
    ds_read_b64_tr_b16 v[100:101], v177 offset:4096
    ds_read_b64_tr_b16 v[102:103], v177 offset:4352
    s_add_u32 m0, s66, 65536
    v_mfma_f32_32x32x16_bf16 v[48:63], v[136:139], a[148:151], v[48:63]
    ds_read_b64_tr_b16 v[104:105], v177 offset:4608
    ds_read_b64_tr_b16 v[106:107], v177 offset:4864
    ds_read_b64_tr_b16 v[108:109], v177 offset:5120
    buffer_load_dwordx4 v164, s[32:35], s48 offen offset:0 lds
    s_add_u32 s61, s61, 65536
    v_lshlrev_b32 v190, 6, v233
    v_mfma_f32_32x32x16_bf16 v[64:79], v[140:143], a[148:151], v[64:79]
    ds_read_b64_tr_b16 v[110:111], v177 offset:5376
    ds_read_b64_tr_b16 v[112:113], v177 offset:5632
    ds_read_b64_tr_b16 v[114:115], v177 offset:5888
    v_xor_b32 v176, 32, v176
    v_add_u32 v190, s61, v190
    v_bfe_u32 v189, v179, 1, 2
    v_mfma_f32_32x32x16_bf16 v[80:95], v[144:147], a[148:151], v[80:95]
    buffer_load_dwordx4 v165, s[32:35], s48 offen offset:1024 lds
    v_lshlrev_b32 v187, 1, v232
    v_xor_b32 v187, v187, v189
    v_lshl_add_u32 v241, v187, 4, v190
    v_xor_b32 v242, 16, v241
    s_waitcnt lgkmcnt(4)
    v_mfma_f32_32x32x16_bf16 v[32:47], v[100:103], a[152:155], v[32:47]
    ds_read_b128 a[156:159], v176
    ds_read_b64_tr_b16 v[132:133], v177 offset:12288
    ds_read_b64_tr_b16 v[134:135], v177 offset:12544
    buffer_load_dwordx4 v166, s[32:35], s48 offen offset:2048 lds
    v_xor_b32 v187, v232, v189
    v_lshl_add_u32 v243, v187, 4, v190
    v_mfma_f32_32x32x16_bf16 v[48:63], v[104:107], a[152:155], v[48:63]
    ds_read_b64_tr_b16 v[136:137], v177 offset:12800
    ds_read_b64_tr_b16 v[138:139], v177 offset:13056
    ds_read_b64_tr_b16 v[140:141], v177 offset:13312
    s_waitcnt lgkmcnt(6)
    v_xor_b32 v244, 32, v243
    v_min_u32 v190, 16, v233
    v_mfma_f32_32x32x16_bf16 v[64:79], v[108:111], a[152:155], v[64:79]
    ds_read_b64_tr_b16 v[142:143], v177 offset:13568
    ds_read_b64_tr_b16 v[144:145], v177 offset:13824
    ds_read_b64_tr_b16 v[146:147], v177 offset:14080
    v_xor_b32 v176, 96, v176
    v_mad_u32_u24 v190, v232, 20, v190
    v_lshlrev_b32 v190, 4, v190
    v_mfma_f32_32x32x16_bf16 v[80:95], v[112:115], a[152:155], v[80:95]
    buffer_load_dwordx4 v167, s[32:35], s48 offen offset:3072 lds
    s_add_u32 m0, m0, 4096
    v_add_u32 v247, 106496, v190
    v_mad_u32_u24 v190, v232, 20, v233
    v_lshlrev_b32 v190, 4, v190
    s_waitcnt lgkmcnt(4)
    v_mfma_f32_32x32x16_bf16 v[32:47], v[132:135], a[156:159], v[32:47]
    ds_read_b128 a[160:163], v176
    ds_read_b64_tr_b16 v[100:101], v177 offset:20480
    ds_read_b64_tr_b16 v[102:103], v177 offset:20736
    buffer_load_dwordx4 v168, s[36:39], s49 offen offset:0 lds
    v_add_u32 v191, 12, v233
    v_lshrrev_b32 v191, 5, v191
    v_mfma_f32_32x32x16_bf16 v[48:63], v[136:139], a[156:159], v[48:63]
    ds_read_b64_tr_b16 v[104:105], v177 offset:20992
    ds_read_b64_tr_b16 v[106:107], v177 offset:21248
    ds_read_b64_tr_b16 v[108:109], v177 offset:21504
    s_waitcnt lgkmcnt(6)
    v_lshl_or_b32 v245, v191, 30, v190
    v_min_u32 v190, 55, v179
    v_mfma_f32_32x32x16_bf16 v[64:79], v[140:143], a[156:159], v[64:79]
    ds_read_b64_tr_b16 v[110:111], v177 offset:21760
    ds_read_b64_tr_b16 v[112:113], v177 offset:22016
    ds_read_b64_tr_b16 v[114:115], v177 offset:22272
    v_xor_b32 v176, 32, v176
    v_lshlrev_b32 v246, 4, v190
    s_lshl_b32 s61, s54, 2
    v_mfma_f32_32x32x16_bf16 v[80:95], v[144:147], a[156:159], v[80:95]
    buffer_load_dwordx4 v168, s[36:39], s49 offen offset:1024 lds
    s_add_u32 s61, s61, s52
    s_mul_i32 s77, s61, 1920
    s_lshl_b32 s0, s77, 4
    s_add_u32 s0, s0, 8388608
    s_waitcnt lgkmcnt(4)
    v_mfma_f32_32x32x16_bf16 v[32:47], v[100:103], a[160:163], v[32:47]
    ds_read_b128 a[164:167], v176
    ds_read_b64_tr_b16 v[132:133], v177 offset:28672
    ds_read_b64_tr_b16 v[134:135], v177 offset:28928
    ds_read_b64_tr_b16 v[136:137], v177 offset:29184
    buffer_load_dwordx4 v170, s[36:39], s49 offen offset:2048 lds
    s_mul_i32 s76, s53, 1920
    v_mfma_f32_32x32x16_bf16 v[48:63], v[104:107], a[160:163], v[48:63]
    ds_read_b64_tr_b16 v[138:139], v177 offset:29440
    ds_read_b64_tr_b16 v[140:141], v177 offset:29696
    ds_read_b64_tr_b16 v[142:143], v177 offset:29952
    ds_read_b64_tr_b16 v[144:145], v177 offset:30208
    s_waitcnt lgkmcnt(8)
    s_add_u32 s76, s76, s0
    v_mfma_f32_32x32x16_bf16 v[64:79], v[108:111], a[160:163], v[64:79]
    ds_read_b64_tr_b16 v[146:147], v177 offset:30464
    buffer_load_dwordx4 v170, s[36:39], s49 offen offset:3072 lds
    s_add_u32 s77, s77, 9371648
    s_lshl_b32 s61, s54, 12
    s_add_u32 s75, s75, s61
    s_add_u32 s75, s75, 90112
    v_mfma_f32_32x32x16_bf16 v[80:95], v[112:115], a[160:163], v[80:95]
    v_add_u32 v176, 32768, v174
    v_add_u32 v177, 32768, v175
    s_add_u32 s48, s48, 128
    s_add_u32 s49, s49, s50
    v_and_b32 v190, 15, v179
    s_waitcnt lgkmcnt(0)
    v_mfma_f32_32x32x16_bf16 v[32:47], v[132:135], a[164:167], v[32:47]
    s_waitcnt vmcnt(8)
    s_barrier
    ds_read_b128 a[168:171], v176
    ds_read_b64_tr_b16 v[100:101], v177 offset:4096
    ds_read_b64_tr_b16 v[102:103], v177 offset:4352
    s_add_u32 m0, s66, 0
    v_mfma_f32_32x32x16_bf16 v[48:63], v[136:139], a[164:167], v[48:63]
    ds_read_b64_tr_b16 v[104:105], v177 offset:4608
    ds_read_b64_tr_b16 v[106:107], v177 offset:4864
    ds_read_b64_tr_b16 v[108:109], v177 offset:5120
    buffer_load_dwordx4 v164, s[32:35], s48 offen offset:0 lds
    v_lshl_add_u32 v190, s53, 4, v190
    v_min_u32 v190, 119, v190
    v_mfma_f32_32x32x16_bf16 v[64:79], v[140:143], a[164:167], v[64:79]
    ds_read_b64_tr_b16 v[110:111], v177 offset:5376
    ds_read_b64_tr_b16 v[112:113], v177 offset:5632
    ds_read_b64_tr_b16 v[114:115], v177 offset:5888
    v_xor_b32 v176, 32, v176
    v_lshlrev_b32 v190, 4, v190
    v_lshrrev_b32 v191, 4, v179
    v_mfma_f32_32x32x16_bf16 v[80:95], v[144:147], a[164:167], v[80:95]
    buffer_load_dwordx4 v165, s[32:35], s48 offen offset:1024 lds
    v_mul_u32_u24 v187, 1920, v191
    s_lshr_b32 s61, s53, 3
    s_lshl_b32 s61, s61, 30
    v_add3_u32 v252, v187, v190, s61
    s_waitcnt lgkmcnt(4)
    v_mfma_f32_32x32x16_bf16 v[32:47], v[100:103], a[168:171], v[32:47]
    ds_read_b128 a[172:175], v176
    ds_read_b64_tr_b16 v[132:133], v177 offset:12288
    ds_read_b64_tr_b16 v[134:135], v177 offset:12544
    buffer_load_dwordx4 v166, s[32:35], s48 offen offset:2048 lds
    v_min_u32 v191, 1, v191
    v_lshl_or_b32 v253, v191, 30, v190
    v_mfma_f32_32x32x16_bf16 v[48:63], v[104:107], a[168:171], v[48:63]
    ds_read_b64_tr_b16 v[136:137], v177 offset:12800
    ds_read_b64_tr_b16 v[138:139], v177 offset:13056
    ds_read_b64_tr_b16 v[140:141], v177 offset:13312
    s_waitcnt lgkmcnt(6)
    v_lshlrev_b32 v190, 4, v193
    v_mov_b32 v191, 0x3f80
    v_mfma_f32_32x32x16_bf16 v[64:79], v[108:111], a[168:171], v[64:79]
    ds_read_b64_tr_b16 v[142:143], v177 offset:13568
    ds_read_b64_tr_b16 v[144:145], v177 offset:13824
    ds_read_b64_tr_b16 v[146:147], v177 offset:14080
    v_xor_b32 v176, 96, v176
    v_lshlrev_b32 v190, v190, v191
    v_mfma_f32_32x32x16_bf16 v[80:95], v[112:115], a[168:171], v[80:95]
    buffer_load_dwordx4 v167, s[32:35], s48 offen offset:3072 lds
    s_add_u32 m0, m0, 4096
    v_cmp_eq_u32 vcc, 0, v189
    s_nop 1
    v_cndmask_b32 v248, 0, v190, vcc
    s_waitcnt lgkmcnt(4)
    v_mfma_f32_32x32x16_bf16 v[32:47], v[132:135], a[172:175], v[32:47]
    ds_read_b128 a[176:179], v176
    ds_read_b64_tr_b16 v[100:101], v177 offset:20480
    ds_read_b64_tr_b16 v[102:103], v177 offset:20736
    buffer_load_dwordx4 v168, s[36:39], s49 offen offset:0 lds
    v_mfma_f32_32x32x16_bf16 v[48:63], v[136:139], a[172:175], v[48:63]
    ds_read_b64_tr_b16 v[104:105], v177 offset:20992
    ds_read_b64_tr_b16 v[106:107], v177 offset:21248
    ds_read_b64_tr_b16 v[108:109], v177 offset:21504
    s_waitcnt lgkmcnt(6)
    v_mfma_f32_32x32x16_bf16 v[64:79], v[140:143], a[172:175], v[64:79]
    ds_read_b64_tr_b16 v[110:111], v177 offset:21760
    ds_read_b64_tr_b16 v[112:113], v177 offset:22016
    ds_read_b64_tr_b16 v[114:115], v177 offset:22272
    v_xor_b32 v176, 32, v176
    v_mfma_f32_32x32x16_bf16 v[80:95], v[144:147], a[172:175], v[80:95]
    buffer_load_dwordx4 v168, s[36:39], s49 offen offset:1024 lds
    v_cmp_eq_u32 vcc, 1, v189
    s_nop 1
    v_cndmask_b32 v249, 0, v190, vcc
    s_waitcnt lgkmcnt(4)
    v_mfma_f32_32x32x16_bf16 v[32:47], v[100:103], a[176:179], v[32:47]
    ds_read_b128 a[180:183], v176
    ds_read_b64_tr_b16 v[132:133], v177 offset:28672
    ds_read_b64_tr_b16 v[134:135], v177 offset:28928
    ds_read_b64_tr_b16 v[136:137], v177 offset:29184
    buffer_load_dwordx4 v170, s[36:39], s49 offen offset:2048 lds
    v_mfma_f32_32x32x16_bf16 v[48:63], v[104:107], a[176:179], v[48:63]
    ds_read_b64_tr_b16 v[138:139], v177 offset:29440
    ds_read_b64_tr_b16 v[140:141], v177 offset:29696
    ds_read_b64_tr_b16 v[142:143], v177 offset:29952
    ds_read_b64_tr_b16 v[144:145], v177 offset:30208
    s_waitcnt lgkmcnt(8)
    v_mfma_f32_32x32x16_bf16 v[64:79], v[108:111], a[176:179], v[64:79]
    ds_read_b64_tr_b16 v[146:147], v177 offset:30464
    buffer_load_dwordx4 v170, s[36:39], s49 offen offset:3072 lds
    v_cmp_eq_u32 vcc, 2, v189
    s_nop 1
    v_cndmask_b32 v250, 0, v190, vcc
    v_mfma_f32_32x32x16_bf16 v[80:95], v[112:115], a[176:179], v[80:95]
    v_add_u32 v176, 65536, v174
    v_add_u32 v177, 65536, v175
    s_add_u32 s48, s48, 128
    s_add_u32 s49, s49, s50
    s_waitcnt lgkmcnt(0)
    v_mfma_f32_32x32x16_bf16 v[32:47], v[132:135], a[180:183], v[32:47]
    s_waitcnt vmcnt(8)
    s_barrier
    ds_read_b128 a[184:187], v176
    ds_read_b64_tr_b16 v[100:101], v177 offset:4096
    ds_read_b64_tr_b16 v[102:103], v177 offset:4352
    s_add_u32 m0, s66, 32768
    v_mfma_f32_32x32x16_bf16 v[48:63], v[136:139], a[180:183], v[48:63]
    ds_read_b64_tr_b16 v[104:105], v177 offset:4608
    ds_read_b64_tr_b16 v[106:107], v177 offset:4864
    ds_read_b64_tr_b16 v[108:109], v177 offset:5120
    buffer_load_dwordx4 v164, s[32:35], s48 offen offset:0 lds
    v_mfma_f32_32x32x16_bf16 v[64:79], v[140:143], a[180:183], v[64:79]
    ds_read_b64_tr_b16 v[110:111], v177 offset:5376
    ds_read_b64_tr_b16 v[112:113], v177 offset:5632
    ds_read_b64_tr_b16 v[114:115], v177 offset:5888
    v_xor_b32 v176, 32, v176
    v_mfma_f32_32x32x16_bf16 v[80:95], v[144:147], a[180:183], v[80:95]
    buffer_load_dwordx4 v165, s[32:35], s48 offen offset:1024 lds
    v_cmp_eq_u32 vcc, 3, v189
    s_nop 1
    v_cndmask_b32 v251, 0, v190, vcc
    v_add_u32 v172, 65536, v185
    s_waitcnt lgkmcnt(4)
    v_mfma_f32_32x32x16_bf16 v[32:47], v[100:103], a[184:187], v[32:47]
    ds_read_b128 a[188:191], v176
    ds_read_b64_tr_b16 v[132:133], v177 offset:12288
    ds_read_b64_tr_b16 v[134:135], v177 offset:12544
    buffer_load_dwordx4 v166, s[32:35], s48 offen offset:2048 lds
    v_add_u32 v173, 72704, v185
    v_mfma_f32_32x32x16_bf16 v[48:63], v[104:107], a[184:187], v[48:63]
    ds_read_b64_tr_b16 v[136:137], v177 offset:12800
    ds_read_b64_tr_b16 v[138:139], v177 offset:13056
    ds_read_b64_tr_b16 v[140:141], v177 offset:13312
    s_waitcnt lgkmcnt(6)
    v_mfma_f32_32x32x16_bf16 v[64:79], v[108:111], a[184:187], v[64:79]
    ds_read_b64_tr_b16 v[142:143], v177 offset:13568
    ds_read_b64_tr_b16 v[144:145], v177 offset:13824
    ds_read_b64_tr_b16 v[146:147], v177 offset:14080
    v_xor_b32 v176, 96, v176
    v_mfma_f32_32x32x16_bf16 v[80:95], v[112:115], a[184:187], v[80:95]
    buffer_load_dwordx4 v167, s[32:35], s48 offen offset:3072 lds
    s_add_u32 m0, m0, 4096
    s_waitcnt lgkmcnt(4)
    v_mfma_f32_32x32x16_bf16 v[32:47], v[132:135], a[188:191], v[32:47]
    ds_read_b128 a[192:195], v176
    ds_read_b64_tr_b16 v[100:101], v177 offset:20480
    ds_read_b64_tr_b16 v[102:103], v177 offset:20736
    buffer_load_dwordx4 v168, s[36:39], s49 offen offset:0 lds
    v_mfma_f32_32x32x16_bf16 v[48:63], v[136:139], a[188:191], v[48:63]
    ds_read_b64_tr_b16 v[104:105], v177 offset:20992
    ds_read_b64_tr_b16 v[106:107], v177 offset:21248
    ds_read_b64_tr_b16 v[108:109], v177 offset:21504
    s_waitcnt lgkmcnt(6)
    v_mfma_f32_32x32x16_bf16 v[64:79], v[140:143], a[188:191], v[64:79]
    ds_read_b64_tr_b16 v[110:111], v177 offset:21760
    ds_read_b64_tr_b16 v[112:113], v177 offset:22016
    ds_read_b64_tr_b16 v[114:115], v177 offset:22272
    v_xor_b32 v176, 32, v176
    v_mfma_f32_32x32x16_bf16 v[80:95], v[144:147], a[188:191], v[80:95]
    buffer_load_dwordx4 v168, s[36:39], s49 offen offset:1024 lds
    s_waitcnt lgkmcnt(4)
    v_mfma_f32_32x32x16_bf16 v[32:47], v[100:103], a[192:195], v[32:47]
    ds_read_b128 a[196:199], v176
    ds_read_b64_tr_b16 v[132:133], v177 offset:28672
    ds_read_b64_tr_b16 v[134:135], v177 offset:28928
    ds_read_b64_tr_b16 v[136:137], v177 offset:29184
    buffer_load_dwordx4 v170, s[36:39], s49 offen offset:2048 lds
    v_mfma_f32_32x32x16_bf16 v[48:63], v[104:107], a[192:195], v[48:63]
    ds_read_b64_tr_b16 v[138:139], v177 offset:29440
    ds_read_b64_tr_b16 v[140:141], v177 offset:29696
    ds_read_b64_tr_b16 v[142:143], v177 offset:29952
    ds_read_b64_tr_b16 v[144:145], v177 offset:30208
    s_waitcnt lgkmcnt(8)
    v_mfma_f32_32x32x16_bf16 v[64:79], v[108:111], a[192:195], v[64:79]
    ds_read_b64_tr_b16 v[146:147], v177 offset:30464
    buffer_load_dwordx4 v170, s[36:39], s49 offen offset:3072 lds
    v_mfma_f32_32x32x16_bf16 v[80:95], v[112:115], a[192:195], v[80:95]
    v_add_u32 v176, 0, v174
    v_add_u32 v177, 0, v175
    s_add_u32 s48, s48, 128
    s_add_u32 s49, s49, s50
    s_waitcnt lgkmcnt(0)
    v_mfma_f32_32x32x16_bf16 v[32:47], v[132:135], a[196:199], v[32:47]
    s_waitcnt vmcnt(8)
    s_barrier
    ds_read_b128 a[200:203], v176
    ds_read_b64_tr_b16 v[100:101], v177 offset:4096
    ds_read_b64_tr_b16 v[102:103], v177 offset:4352
    s_add_u32 m0, s66, 65536
    v_mfma_f32_32x32x16_bf16 v[48:63], v[136:139], a[196:199], v[48:63]
    ds_read_b64_tr_b16 v[104:105], v177 offset:4608
    ds_read_b64_tr_b16 v[106:107], v177 offset:4864
    ds_read_b64_tr_b16 v[108:109], v177 offset:5120
    buffer_load_dwordx4 v164, s[32:35], s48 offen offset:0 lds
    v_add_u32 v164, 0, v199
    v_mfma_f32_32x32x16_bf16 v[64:79], v[140:143], a[196:199], v[64:79]
    ds_read_b64_tr_b16 v[110:111], v177 offset:5376
    ds_read_b64_tr_b16 v[112:113], v177 offset:5632
    ds_read_b64_tr_b16 v[114:115], v177 offset:5888
    v_xor_b32 v176, 32, v176
    v_mfma_f32_32x32x16_bf16 v[80:95], v[144:147], a[196:199], v[80:95]
    buffer_load_dwordx4 v165, s[32:35], s48 offen offset:1024 lds
    v_add_u32 v165, 23552, v199
    s_waitcnt lgkmcnt(4)
    v_mfma_f32_32x32x16_bf16 v[32:47], v[100:103], a[200:203], v[32:47]
    ds_read_b128 a[204:207], v176
    ds_read_b64_tr_b16 v[132:133], v177 offset:12288
    ds_read_b64_tr_b16 v[134:135], v177 offset:12544
    buffer_load_dwordx4 v166, s[32:35], s48 offen offset:2048 lds
    v_add_u32 v166, 47104, v199
    v_mfma_f32_32x32x16_bf16 v[48:63], v[104:107], a[200:203], v[48:63]
    ds_read_b64_tr_b16 v[136:137], v177 offset:12800
    ds_read_b64_tr_b16 v[138:139], v177 offset:13056
    ds_read_b64_tr_b16 v[140:141], v177 offset:13312
    s_waitcnt lgkmcnt(6)
    v_mfma_f32_32x32x16_bf16 v[64:79], v[108:111], a[200:203], v[64:79]
    ds_read_b64_tr_b16 v[142:143], v177 offset:13568
    ds_read_b64_tr_b16 v[144:145], v177 offset:13824
    ds_read_b64_tr_b16 v[146:147], v177 offset:14080
    v_xor_b32 v176, 96, v176
    v_mfma_f32_32x32x16_bf16 v[80:95], v[112:115], a[200:203], v[80:95]
    buffer_load_dwordx4 v167, s[32:35], s48 offen offset:3072 lds
    v_add_u32 v167, 70656, v199
    s_add_u32 m0, m0, 4096
    s_waitcnt lgkmcnt(4)
    v_mfma_f32_32x32x16_bf16 v[32:47], v[132:135], a[204:207], v[32:47]
    ds_read_b128 a[208:211], v176
    ds_read_b64_tr_b16 v[100:101], v177 offset:20480
    ds_read_b64_tr_b16 v[102:103], v177 offset:20736
    buffer_load_dwordx4 v168, s[36:39], s49 offen offset:0 lds
    v_add_u32 v169, 121856, v199
    v_mfma_f32_32x32x16_bf16 v[48:63], v[136:139], a[204:207], v[48:63]
    ds_read_b64_tr_b16 v[104:105], v177 offset:20992
    ds_read_b64_tr_b16 v[106:107], v177 offset:21248
    ds_read_b64_tr_b16 v[108:109], v177 offset:21504
    s_waitcnt lgkmcnt(6)
    v_mfma_f32_32x32x16_bf16 v[64:79], v[140:143], a[204:207], v[64:79]
    ds_read_b64_tr_b16 v[110:111], v177 offset:21760
    ds_read_b64_tr_b16 v[112:113], v177 offset:22016
    ds_read_b64_tr_b16 v[114:115], v177 offset:22272
    v_xor_b32 v176, 32, v176
    v_mfma_f32_32x32x16_bf16 v[80:95], v[144:147], a[204:207], v[80:95]
    buffer_load_dwordx4 v168, s[36:39], s49 offen offset:1024 lds
    v_add_u32 v168, 98304, v199
    s_waitcnt lgkmcnt(4)
    v_mfma_f32_32x32x16_bf16 v[32:47], v[100:103], a[208:211], v[32:47]
    ds_read_b128 a[212:215], v176
    ds_read_b64_tr_b16 v[132:133], v177 offset:28672
    ds_read_b64_tr_b16 v[134:135], v177 offset:28928
    ds_read_b64_tr_b16 v[136:137], v177 offset:29184
    buffer_load_dwordx4 v170, s[36:39], s49 offen offset:2048 lds
    v_add_u32 v171, 168960, v199
    v_mfma_f32_32x32x16_bf16 v[48:63], v[104:107], a[208:211], v[48:63]
    ds_read_b64_tr_b16 v[138:139], v177 offset:29440
    ds_read_b64_tr_b16 v[140:141], v177 offset:29696
    ds_read_b64_tr_b16 v[142:143], v177 offset:29952
    ds_read_b64_tr_b16 v[144:145], v177 offset:30208
    s_waitcnt lgkmcnt(8)
    v_mfma_f32_32x32x16_bf16 v[64:79], v[108:111], a[208:211], v[64:79]
    ds_read_b64_tr_b16 v[146:147], v177 offset:30464
    buffer_load_dwordx4 v170, s[36:39], s49 offen offset:3072 lds
    v_add_u32 v170, 145408, v199
    v_mfma_f32_32x32x16_bf16 v[80:95], v[112:115], a[208:211], v[80:95]
    v_add_u32 v176, 32768, v174
    v_add_u32 v177, 32768, v175
    s_mov_b32 s48, 0
    s_mov_b32 s49, 0
    s_cmp_lg_u32 s52, 1
    s_cbranch_scc1 L_pf4e
    s_mov_b32 s44, s18
    s_mov_b32 s45, s19
    s_mov_b32 s46, 1409024
    s_mov_b32 s47, 0x20000
    buffer_load_dword v255, v236, s[44:47], 0 offen
    v_subrev_u32 v236, 1409024, v236
    s_mov_b32 s44, s10
    s_mov_b32 s45, s11
    s_mov_b32 s46, 524288
    s_mov_b32 s47, 0x20000
    buffer_load_dword v255, v236, s[44:47], 0 offen
L_pf4e:
    s_waitcnt lgkmcnt(0)
    v_mfma_f32_32x32x16_bf16 v[32:47], v[132:135], a[212:215], v[32:47]
    s_waitcnt vmcnt(8)
    s_barrier
    ds_read_b128 a[216:219], v176
    ds_read_b64_tr_b16 v[100:101], v177 offset:4096
    ds_read_b64_tr_b16 v[102:103], v177 offset:4352
    s_add_u32 m0, s66, 0
    v_mfma_f32_32x32x16_bf16 v[48:63], v[136:139], a[212:215], v[48:63]
    ds_read_b64_tr_b16 v[104:105], v177 offset:4608
    ds_read_b64_tr_b16 v[106:107], v177 offset:4864
    ds_read_b64_tr_b16 v[108:109], v177 offset:5120
    buffer_load_dwordx4 v164, s[36:39], s48 offen offset:0 lds
    s_mov_b32 s32, s18
    s_mov_b32 s33, s19
    v_mfma_f32_32x32x16_bf16 v[64:79], v[140:143], a[212:215], v[64:79]
    ds_read_b64_tr_b16 v[110:111], v177 offset:5376
    ds_read_b64_tr_b16 v[112:113], v177 offset:5632
    ds_read_b64_tr_b16 v[114:115], v177 offset:5888
    v_xor_b32 v176, 32, v176
    s_mov_b32 s34, 1409024
    s_mov_b32 s35, 0x20000
    v_mfma_f32_32x32x16_bf16 v[80:95], v[144:147], a[212:215], v[80:95]
    buffer_load_dwordx4 v165, s[36:39], s48 offen offset:1024 lds
    v_xor_b32 v200, v197, v200
    v_xor_b32 v201, v197, v201
    v_xor_b32 v202, v197, v202
    v_xor_b32 v203, v197, v203
    s_waitcnt lgkmcnt(4)
    v_mfma_f32_32x32x16_bf16 v[32:47], v[100:103], a[216:219], v[32:47]
    ds_read_b128 a[220:223], v176
    ds_read_b64_tr_b16 v[132:133], v177 offset:12288
    ds_read_b64_tr_b16 v[134:135], v177 offset:12544
    buffer_load_dwordx4 v166, s[36:39], s48 offen offset:2048 lds
    v_xor_b32 v204, v197, v204
    v_xor_b32 v205, v197, v205
    v_mfma_f32_32x32x16_bf16 v[48:63], v[104:107], a[216:219], v[48:63]
    ds_read_b64_tr_b16 v[136:137], v177 offset:12800
    ds_read_b64_tr_b16 v[138:139], v177 offset:13056
    ds_read_b64_tr_b16 v[140:141], v177 offset:13312
    s_waitcnt lgkmcnt(6)
    v_xor_b32 v206, v197, v206
    v_xor_b32 v207, v197, v207
    v_mfma_f32_32x32x16_bf16 v[64:79], v[108:111], a[216:219], v[64:79]
    ds_read_b64_tr_b16 v[142:143], v177 offset:13568
    ds_read_b64_tr_b16 v[144:145], v177 offset:13824
    ds_read_b64_tr_b16 v[146:147], v177 offset:14080
    v_xor_b32 v176, 96, v176
    v_xor_b32 v208, v197, v208
    v_xor_b32 v209, v197, v209
    v_mfma_f32_32x32x16_bf16 v[80:95], v[112:115], a[216:219], v[80:95]
    buffer_load_dwordx4 v167, s[36:39], s48 offen offset:3072 lds
    s_add_u32 m0, m0, 4096
    v_xor_b32 v210, v197, v210
    v_xor_b32 v211, v197, v211
    v_xor_b32 v212, v197, v212
    s_waitcnt lgkmcnt(4)
    v_mfma_f32_32x32x16_bf16 v[32:47], v[132:135], a[220:223], v[32:47]
    ds_read_b128 a[224:227], v176
    ds_read_b64_tr_b16 v[100:101], v177 offset:20480
    ds_read_b64_tr_b16 v[102:103], v177 offset:20736
    buffer_load_dwordx4 v168, s[36:39], s49 offen offset:0 lds
    v_xor_b32 v213, v197, v213
    v_xor_b32 v214, v197, v214
    v_mfma_f32_32x32x16_bf16 v[48:63], v[136:139], a[220:223], v[48:63]
    ds_read_b64_tr_b16 v[104:105], v177 offset:20992
    ds_read_b64_tr_b16 v[106:107], v177 offset:21248
    ds_read_b64_tr_b16 v[108:109], v177 offset:21504
    s_waitcnt lgkmcnt(6)
    v_xor_b32 v215, v197, v215
    v_mfma_f32_32x32x16_bf16 v[64:79], v[140:143], a[220:223], v[64:79]
    ds_read_b64_tr_b16 v[110:111], v177 offset:21760
    ds_read_b64_tr_b16 v[112:113], v177 offset:22016
    ds_read_b64_tr_b16 v[114:115], v177 offset:22272
    v_xor_b32 v176, 32, v176
    v_mfma_f32_32x32x16_bf16 v[80:95], v[144:147], a[220:223], v[80:95]
    buffer_load_dwordx4 v169, s[36:39], s49 offen offset:1024 lds
    s_waitcnt lgkmcnt(4)
    v_mfma_f32_32x32x16_bf16 v[32:47], v[100:103], a[224:227], v[32:47]
    ds_read_b128 a[228:231], v176
    ds_read_b64_tr_b16 v[132:133], v177 offset:28672
    ds_read_b64_tr_b16 v[134:135], v177 offset:28928
    ds_read_b64_tr_b16 v[136:137], v177 offset:29184
    buffer_load_dwordx4 v170, s[36:39], s49 offen offset:2048 lds
    v_mfma_f32_32x32x16_bf16 v[48:63], v[104:107], a[224:227], v[48:63]
    ds_read_b64_tr_b16 v[138:139], v177 offset:29440
    ds_read_b64_tr_b16 v[140:141], v177 offset:29696
    ds_read_b64_tr_b16 v[142:143], v177 offset:29952
    ds_read_b64_tr_b16 v[144:145], v177 offset:30208
    s_waitcnt lgkmcnt(8)
    v_mfma_f32_32x32x16_bf16 v[64:79], v[108:111], a[224:227], v[64:79]
    ds_read_b64_tr_b16 v[146:147], v177 offset:30464
    buffer_load_dwordx4 v171, s[36:39], s49 offen offset:3072 lds
    v_mfma_f32_32x32x16_bf16 v[80:95], v[112:115], a[224:227], v[80:95]
    v_add_u32 v176, 65536, v174
    v_add_u32 v177, 65536, v175
    s_mov_b32 s48, 786432
    s_mov_b32 s49, 786432
    global_load_dword v184, v181, s[26:27] sc1
    s_waitcnt lgkmcnt(0)
    v_mfma_f32_32x32x16_bf16 v[32:47], v[132:135], a[228:231], v[32:47]
    s_waitcnt vmcnt(9)
    s_barrier
    ds_read_b128 a[232:235], v176
    ds_read_b64_tr_b16 v[100:101], v177 offset:4096
    ds_read_b64_tr_b16 v[102:103], v177 offset:4352
    s_add_u32 m0, s66, 32768
    v_mfma_f32_32x32x16_bf16 v[48:63], v[136:139], a[228:231], v[48:63]
    ds_read_b64_tr_b16 v[104:105], v177 offset:4608
    ds_read_b64_tr_b16 v[106:107], v177 offset:4864
    ds_read_b64_tr_b16 v[108:109], v177 offset:5120
    buffer_load_dwordx4 v164, s[36:39], s48 offen offset:0 lds
    v_add_u32 v164, 0, v185
    v_mfma_f32_32x32x16_bf16 v[64:79], v[140:143], a[228:231], v[64:79]
    ds_read_b64_tr_b16 v[110:111], v177 offset:5376
    ds_read_b64_tr_b16 v[112:113], v177 offset:5632
    ds_read_b64_tr_b16 v[114:115], v177 offset:5888
    v_xor_b32 v176, 32, v176
    v_mfma_f32_32x32x16_bf16 v[80:95], v[144:147], a[228:231], v[80:95]
    buffer_load_dwordx4 v165, s[36:39], s48 offen offset:1024 lds
    v_add_u32 v165, 7168, v185
    s_waitcnt lgkmcnt(4)
    v_mfma_f32_32x32x16_bf16 v[32:47], v[100:103], a[232:235], v[32:47]
    ds_read_b128 a[236:239], v176
    ds_read_b64_tr_b16 v[132:133], v177 offset:12288
    ds_read_b64_tr_b16 v[134:135], v177 offset:12544
    buffer_load_dwordx4 v166, s[36:39], s48 offen offset:2048 lds
    v_add_u32 v166, 14336, v185
    v_mfma_f32_32x32x16_bf16 v[48:63], v[104:107], a[232:235], v[48:63]
    ds_read_b64_tr_b16 v[136:137], v177 offset:12800
    ds_read_b64_tr_b16 v[138:139], v177 offset:13056
    ds_read_b64_tr_b16 v[140:141], v177 offset:13312
    s_waitcnt lgkmcnt(6)
    v_mfma_f32_32x32x16_bf16 v[64:79], v[108:111], a[232:235], v[64:79]
    ds_read_b64_tr_b16 v[142:143], v177 offset:13568
    ds_read_b64_tr_b16 v[144:145], v177 offset:13824
    ds_read_b64_tr_b16 v[146:147], v177 offset:14080
    v_xor_b32 v176, 96, v176
    v_mfma_f32_32x32x16_bf16 v[80:95], v[112:115], a[232:235], v[80:95]
    buffer_load_dwordx4 v167, s[36:39], s48 offen offset:3072 lds
    v_add_u32 v167, 21504, v185
    s_add_u32 m0, m0, 4096
    s_waitcnt lgkmcnt(4)
    v_mfma_f32_32x32x16_bf16 v[32:47], v[132:135], a[236:239], v[32:47]
    ds_read_b128 a[240:243], v176
    ds_read_b64_tr_b16 v[100:101], v177 offset:20480
    ds_read_b64_tr_b16 v[102:103], v177 offset:20736
    buffer_load_dwordx4 v168, s[36:39], s49 offen offset:0 lds
    v_add_u32 v168, 32768, v185
    v_mfma_f32_32x32x16_bf16 v[48:63], v[136:139], a[236:239], v[48:63]
    ds_read_b64_tr_b16 v[104:105], v177 offset:20992
    ds_read_b64_tr_b16 v[106:107], v177 offset:21248
    ds_read_b64_tr_b16 v[108:109], v177 offset:21504
    s_waitcnt lgkmcnt(6)
    v_mfma_f32_32x32x16_bf16 v[64:79], v[140:143], a[236:239], v[64:79]
    ds_read_b64_tr_b16 v[110:111], v177 offset:21760
    ds_read_b64_tr_b16 v[112:113], v177 offset:22016
    ds_read_b64_tr_b16 v[114:115], v177 offset:22272
    v_xor_b32 v176, 32, v176
    v_mfma_f32_32x32x16_bf16 v[80:95], v[144:147], a[236:239], v[80:95]
    buffer_load_dwordx4 v169, s[36:39], s49 offen offset:1024 lds
    v_add_u32 v169, 39936, v185
    s_waitcnt lgkmcnt(4)
    v_mfma_f32_32x32x16_bf16 v[32:47], v[100:103], a[240:243], v[32:47]
    ds_read_b128 a[244:247], v176
    ds_read_b64_tr_b16 v[132:133], v177 offset:28672
    ds_read_b64_tr_b16 v[134:135], v177 offset:28928
    ds_read_b64_tr_b16 v[136:137], v177 offset:29184
    buffer_load_dwordx4 v170, s[36:39], s49 offen offset:2048 lds
    v_add_u32 v170, 47104, v185
    v_mfma_f32_32x32x16_bf16 v[48:63], v[104:107], a[240:243], v[48:63]
    ds_read_b64_tr_b16 v[138:139], v177 offset:29440
    ds_read_b64_tr_b16 v[140:141], v177 offset:29696
    ds_read_b64_tr_b16 v[142:143], v177 offset:29952
    ds_read_b64_tr_b16 v[144:145], v177 offset:30208
    s_waitcnt lgkmcnt(8)
    v_mfma_f32_32x32x16_bf16 v[64:79], v[108:111], a[240:243], v[64:79]
    ds_read_b64_tr_b16 v[146:147], v177 offset:30464
    buffer_load_dwordx4 v171, s[36:39], s49 offen offset:3072 lds
    v_add_u32 v171, 54272, v185
    v_mfma_f32_32x32x16_bf16 v[80:95], v[112:115], a[240:243], v[80:95]
    s_waitcnt lgkmcnt(0)
    v_mfma_f32_32x32x16_bf16 v[32:47], v[132:135], a[244:247], v[32:47]
    s_barrier
    v_mfma_f32_32x32x16_bf16 v[48:63], v[136:139], a[244:247], v[48:63]
    s_waitcnt vmcnt(8)
    v_readfirstlane_b32 s65, v184
    v_mfma_f32_32x32x16_bf16 v[64:79], v[140:143], a[244:247], v[64:79]
    s_cmp_eq_u32 s65, 0
    s_cbranch_scc1 L_tag5_r
L_tag5_ok:
    v_mfma_f32_32x32x16_bf16 v[80:95], v[144:147], a[244:247], v[80:95]
    s_sub_u32 s36, s10, 32768
    s_subb_u32 s37, s11, 0
    s_mov_b32 s38, 557056
    s_mov_b32 s39, 0x20000
    s_nop 0
    s_nop 0
    v_cvt_pk_bf16_f32 v32, v32, v33
    v_cvt_pk_bf16_f32 v33, v34, v35
    v_cvt_pk_bf16_f32 v34, v36, v37
    v_cvt_pk_bf16_f32 v35, v38, v39
    v_cvt_pk_bf16_f32 v40, v40, v41
    v_cvt_pk_bf16_f32 v41, v42, v43
    v_cvt_pk_bf16_f32 v42, v44, v45
    v_cvt_pk_bf16_f32 v43, v46, v47
    v_mfma_f32_32x32x16_bf16 v[100:115], v[200:203], v[32:35], 0
    v_cvt_pk_bf16_f32 v48, v48, v49
    v_cvt_pk_bf16_f32 v49, v50, v51
    v_cvt_pk_bf16_f32 v50, v52, v53
    v_cvt_pk_bf16_f32 v51, v54, v55
    v_mfma_f32_32x32x16_bf16 v[116:131], v[204:207], v[40:43], 0
    v_cvt_pk_bf16_f32 v56, v56, v57
    v_cvt_pk_bf16_f32 v57, v58, v59
    v_cvt_pk_bf16_f32 v58, v60, v61
    v_cvt_pk_bf16_f32 v59, v62, v63
    v_mfma_f32_32x32x16_bf16 v[132:147], v[208:211], v[48:51], 0
    v_cvt_pk_bf16_f32 v64, v64, v65
    v_cvt_pk_bf16_f32 v65, v66, v67
    v_cvt_pk_bf16_f32 v66, v68, v69
    v_cvt_pk_bf16_f32 v67, v70, v71
    v_mfma_f32_32x32x16_bf16 v[148:163], v[212:215], v[56:59], 0
    ds_write_b128 v243, v[64:67] offset:32768
    v_cvt_pk_bf16_f32 v72, v72, v73
    v_cvt_pk_bf16_f32 v73, v74, v75
    v_cvt_pk_bf16_f32 v74, v76, v77
    v_cvt_pk_bf16_f32 v75, v78, v79
    ds_write_b128 v244, v[72:75] offset:32768
    v_cvt_pk_bf16_f32 v80, v80, v81
    v_cvt_pk_bf16_f32 v81, v82, v83
    v_cvt_pk_bf16_f32 v82, v84, v85
    v_cvt_pk_bf16_f32 v83, v86, v87
    ds_write_b128 v243, v[80:83] offset:40960
    v_cvt_pk_bf16_f32 v88, v88, v89
    v_cvt_pk_bf16_f32 v89, v90, v91
    v_cvt_pk_bf16_f32 v90, v92, v93
    v_cvt_pk_bf16_f32 v91, v94, v95
    ds_write_b128 v244, v[88:91] offset:40960
    v_max3_f32 v186, v100, v101, v102
    v_max3_f32 v187, v103, v104, v105
    v_max3_f32 v186, v186, v106, v107
    v_max3_f32 v187, v187, v108, v109
    v_max3_f32 v186, v186, v110, v111
    v_max3_f32 v187, v187, v112, v113
    v_max3_f32 v186, v186, v114, v115
    v_max_f32_e64 v186, v186, v187
    v_mul_f32 v186, 0xbfb8aa3b, v186
    v_pk_fma_f32 v[100:101], v[100:101], s[70:71], v[186:187] op_sel_hi:[1,1,0]
    v_pk_fma_f32 v[102:103], v[102:103], s[70:71], v[186:187] op_sel_hi:[1,1,0]
    v_pk_fma_f32 v[104:105], v[104:105], s[70:71], v[186:187] op_sel_hi:[1,1,0]
    v_pk_fma_f32 v[106:107], v[106:107], s[70:71], v[186:187] op_sel_hi:[1,1,0]
    v_pk_fma_f32 v[108:109], v[108:109], s[70:71], v[186:187] op_sel_hi:[1,1,0]
    v_pk_fma_f32 v[110:111], v[110:111], s[70:71], v[186:187] op_sel_hi:[1,1,0]
    v_pk_fma_f32 v[112:113], v[112:113], s[70:71], v[186:187] op_sel_hi:[1,1,0]
    v_pk_fma_f32 v[114:115], v[114:115], s[70:71], v[186:187] op_sel_hi:[1,1,0]
    v_exp_f32 v100, v100
    v_exp_f32 v101, v101
    v_exp_f32 v102, v102
    v_exp_f32 v103, v103
    v_exp_f32 v104, v104
    v_exp_f32 v105, v105
    v_exp_f32 v106, v106
    v_exp_f32 v107, v107
    v_exp_f32 v108, v108
    v_exp_f32 v109, v109
    v_exp_f32 v110, v110
    v_exp_f32 v111, v111
    v_exp_f32 v112, v112
    v_exp_f32 v113, v113
    v_exp_f32 v114, v114
    v_exp_f32 v115, v115
    v_pk_add_f32 v[186:187], v[100:101], v[102:103]
    v_pk_add_f32 v[188:189], v[104:105], v[106:107]
    v_pk_add_f32 v[186:187], v[186:187], v[108:109]
    v_pk_add_f32 v[188:189], v[188:189], v[110:111]
    v_pk_add_f32 v[186:187], v[186:187], v[112:113]
    v_pk_add_f32 v[188:189], v[188:189], v[114:115]
    v_pk_add_f32 v[186:187], v[186:187], v[188:189]
    v_add_f32_e64 v186, v186, v187
    v_rcp_f32 v186, v186
    s_nop 0
    v_pk_mul_f32 v[100:101], v[100:101], v[186:187] op_sel_hi:[1,0]
    v_pk_mul_f32 v[102:103], v[102:103], v[186:187] op_sel_hi:[1,0]
    v_pk_mul_f32 v[104:105], v[104:105], v[186:187] op_sel_hi:[1,0]
    v_pk_mul_f32 v[106:107], v[106:107], v[186:187] op_sel_hi:[1,0]
    v_pk_mul_f32 v[108:109], v[108:109], v[186:187] op_sel_hi:[1,0]
    v_pk_mul_f32 v[110:111], v[110:111], v[186:187] op_sel_hi:[1,0]
    v_pk_mul_f32 v[112:113], v[112:113], v[186:187] op_sel_hi:[1,0]
    v_pk_mul_f32 v[114:115], v[114:115], v[186:187] op_sel_hi:[1,0]
    v_cvt_pk_bf16_f32 v32, v100, v101
    v_cvt_pk_bf16_f32 v33, v102, v103
    v_cvt_pk_bf16_f32 v34, v104, v105
    v_cvt_pk_bf16_f32 v35, v106, v107
    v_cvt_pk_bf16_f32 v36, v108, v109
    v_cvt_pk_bf16_f32 v37, v110, v111
    v_cvt_pk_bf16_f32 v38, v112, v113
    v_cvt_pk_bf16_f32 v39, v114, v115
    ds_write_b128 v241, v[32:35] offset:0
    ds_write_b128 v242, v[36:39] offset:0
    v_max3_f32 v186, v116, v117, v118
    v_max3_f32 v187, v119, v120, v121
    v_max3_f32 v186, v186, v122, v123
    v_max3_f32 v187, v187, v124, v125
    v_max3_f32 v186, v186, v126, v127
    v_max3_f32 v187, v187, v128, v129
    v_max3_f32 v186, v186, v130, v131
    s_add_u32 s48, s58, 0
    s_nop 0
    v_max_f32_e64 v186, v186, v187
    v_mul_f32 v186, 0xbfb8aa3b, v186
    v_pk_fma_f32 v[116:117], v[116:117], s[70:71], v[186:187] op_sel_hi:[1,1,0]
    v_pk_fma_f32 v[118:119], v[118:119], s[70:71], v[186:187] op_sel_hi:[1,1,0]
    v_pk_fma_f32 v[120:121], v[120:121], s[70:71], v[186:187] op_sel_hi:[1,1,0]
    v_pk_fma_f32 v[122:123], v[122:123], s[70:71], v[186:187] op_sel_hi:[1,1,0]
    v_pk_fma_f32 v[124:125], v[124:125], s[70:71], v[186:187] op_sel_hi:[1,1,0]
    s_add_u32 s49, s58, 0
    v_pk_fma_f32 v[126:127], v[126:127], s[70:71], v[186:187] op_sel_hi:[1,1,0]
    v_pk_fma_f32 v[128:129], v[128:129], s[70:71], v[186:187] op_sel_hi:[1,1,0]
    v_pk_fma_f32 v[130:131], v[130:131], s[70:71], v[186:187] op_sel_hi:[1,1,0]
    v_exp_f32 v116, v116
    v_exp_f32 v117, v117
    v_exp_f32 v118, v118
    v_exp_f32 v119, v119
    s_add_u32 m0, s72, 114688
    v_exp_f32 v120, v120
    v_exp_f32 v121, v121
    v_exp_f32 v122, v122
    v_exp_f32 v123, v123
    v_exp_f32 v124, v124
    v_exp_f32 v125, v125
    v_exp_f32 v126, v126
    buffer_load_dwordx4 v164, s[32:35], s48 offen offset:0 lds
    v_exp_f32 v127, v127
    v_exp_f32 v128, v128
    v_exp_f32 v129, v129
    v_exp_f32 v130, v130
    v_exp_f32_e64 v131, v131
    v_pk_add_f32 v[186:187], v[116:117], v[118:119]
    v_pk_add_f32 v[188:189], v[120:121], v[122:123]
    buffer_load_dwordx4 v165, s[32:35], s48 offen offset:1024 lds
    v_pk_add_f32 v[186:187], v[186:187], v[124:125]
    v_pk_add_f32 v[188:189], v[188:189], v[126:127]
    v_pk_add_f32 v[186:187], v[186:187], v[128:129]
    v_pk_add_f32 v[188:189], v[188:189], v[130:131]
    v_pk_add_f32 v[186:187], v[186:187], v[188:189]
    v_add_f32_e64 v186, v186, v187
    v_rcp_f32 v186, v186
    buffer_load_dwordx4 v166, s[32:35], s48 offen offset:2048 lds
    s_nop 0
    v_pk_mul_f32 v[116:117], v[116:117], v[186:187] op_sel_hi:[1,0]
    v_pk_mul_f32 v[118:119], v[118:119], v[186:187] op_sel_hi:[1,0]
    v_pk_mul_f32 v[120:121], v[120:121], v[186:187] op_sel_hi:[1,0]
    v_pk_mul_f32 v[122:123], v[122:123], v[186:187] op_sel_hi:[1,0]
    v_pk_mul_f32 v[124:125], v[124:125], v[186:187] op_sel_hi:[1,0]
    v_pk_mul_f32 v[126:127], v[126:127], v[186:187] op_sel_hi:[1,0]
    buffer_load_dwordx4 v167, s[32:35], s48 offen offset:3072 lds
    v_pk_mul_f32 v[128:129], v[128:129], v[186:187] op_sel_hi:[1,0]
    v_pk_mul_f32 v[130:131], v[130:131], v[186:187] op_sel_hi:[1,0]
    v_cvt_pk_bf16_f32 v40, v116, v117
    v_cvt_pk_bf16_f32 v41, v118, v119
    v_cvt_pk_bf16_f32 v42, v120, v121
    v_cvt_pk_bf16_f32 v43, v122, v123
    v_cvt_pk_bf16_f32 v44, v124, v125
    s_add_u32 m0, m0, 4096
    v_cvt_pk_bf16_f32 v45, v126, v127
    v_cvt_pk_bf16_f32 v46, v128, v129
    v_cvt_pk_bf16_f32 v47, v130, v131
    ds_write_b128 v241, v[40:43] offset:8192
    ds_write_b128 v242, v[44:47] offset:8192
    v_max3_f32 v186, v132, v133, v134
    v_max3_f32 v187, v135, v136, v137
    v_max3_f32 v186, v186, v138, v139
    v_max3_f32 v187, v187, v140, v141
    v_max3_f32 v186, v186, v142, v143
    v_max3_f32 v187, v187, v144, v145
    v_max3_f32 v186, v186, v146, v147
    buffer_load_dwordx4 v168, s[32:35], s49 offen offset:0 lds
    v_max_f32_e64 v186, v186, v187
    v_mul_f32 v186, 0xbfb8aa3b, v186
    v_pk_fma_f32 v[132:133], v[132:133], s[70:71], v[186:187] op_sel_hi:[1,1,0]
    v_pk_fma_f32 v[134:135], v[134:135], s[70:71], v[186:187] op_sel_hi:[1,1,0]
    v_pk_fma_f32 v[136:137], v[136:137], s[70:71], v[186:187] op_sel_hi:[1,1,0]
    v_pk_fma_f32 v[138:139], v[138:139], s[70:71], v[186:187] op_sel_hi:[1,1,0]
    v_pk_fma_f32 v[140:141], v[140:141], s[70:71], v[186:187] op_sel_hi:[1,1,0]
    buffer_load_dwordx4 v169, s[32:35], s49 offen offset:1024 lds
    v_pk_fma_f32 v[142:143], v[142:143], s[70:71], v[186:187] op_sel_hi:[1,1,0]
    v_pk_fma_f32 v[144:145], v[144:145], s[70:71], v[186:187] op_sel_hi:[1,1,0]
    v_pk_fma_f32 v[146:147], v[146:147], s[70:71], v[186:187] op_sel_hi:[1,1,0]
    v_exp_f32 v132, v132
    v_exp_f32 v133, v133
    v_exp_f32 v134, v134
    v_exp_f32 v135, v135
    buffer_load_dwordx4 v170, s[32:35], s49 offen offset:2048 lds
    v_exp_f32 v136, v136
    v_exp_f32 v137, v137
    v_exp_f32 v138, v138
    v_exp_f32 v139, v139
    v_exp_f32 v140, v140
    v_exp_f32 v141, v141
    v_exp_f32 v142, v142
    buffer_load_dwordx4 v171, s[32:35], s49 offen offset:3072 lds
    v_exp_f32 v143, v143
    v_exp_f32 v144, v144
    v_exp_f32 v145, v145
    v_exp_f32 v146, v146
    v_exp_f32 v147, v147
    v_pk_add_f32 v[186:187], v[132:133], v[134:135]
    v_pk_add_f32 v[188:189], v[136:137], v[138:139]
    s_add_u32 m0, m0, 4096
    v_pk_add_f32 v[186:187], v[186:187], v[140:141]
    v_pk_add_f32 v[188:189], v[188:189], v[142:143]
    v_pk_add_f32 v[186:187], v[186:187], v[144:145]
    v_pk_add_f32 v[188:189], v[188:189], v[146:147]
    v_pk_add_f32 v[186:187], v[186:187], v[188:189]
    v_add_f32_e64 v186, v186, v187
    v_rcp_f32 v186, v186
    buffer_load_dwordx4 v172, s[32:35], s49 offen offset:0 lds
    s_nop 0
    v_pk_mul_f32 v[132:133], v[132:133], v[186:187] op_sel_hi:[1,0]
    v_pk_mul_f32 v[134:135], v[134:135], v[186:187] op_sel_hi:[1,0]
    v_pk_mul_f32 v[136:137], v[136:137], v[186:187] op_sel_hi:[1,0]
    v_pk_mul_f32 v[138:139], v[138:139], v[186:187] op_sel_hi:[1,0]
    v_pk_mul_f32 v[140:141], v[140:141], v[186:187] op_sel_hi:[1,0]
    v_pk_mul_f32 v[142:143], v[142:143], v[186:187] op_sel_hi:[1,0]
    buffer_load_dwordx4 v173, s[32:35], s49 offen offset:1024 lds
    v_pk_mul_f32 v[144:145], v[144:145], v[186:187] op_sel_hi:[1,0]
    v_pk_mul_f32 v[146:147], v[146:147], v[186:187] op_sel_hi:[1,0]
    v_cvt_pk_bf16_f32 v48, v132, v133
    v_cvt_pk_bf16_f32 v49, v134, v135
    v_cvt_pk_bf16_f32 v50, v136, v137
    v_cvt_pk_bf16_f32 v51, v138, v139
    v_cvt_pk_bf16_f32 v52, v140, v141
    v_cvt_pk_bf16_f32 v53, v142, v143
    v_cvt_pk_bf16_f32 v54, v144, v145
    v_cvt_pk_bf16_f32 v55, v146, v147
    ds_write_b128 v241, v[48:51] offset:16384
    ds_write_b128 v242, v[52:55] offset:16384
    v_max3_f32 v186, v148, v149, v150
    v_max3_f32 v187, v151, v152, v153
    v_max3_f32 v186, v186, v154, v155
    v_max3_f32 v187, v187, v156, v157
    v_max3_f32 v186, v186, v158, v159
    v_max3_f32 v187, v187, v160, v161
    v_max3_f32 v186, v186, v162, v163
    v_max_f32_e64 v186, v186, v187
    v_mul_f32 v186, 0xbfb8aa3b, v186
    v_pk_fma_f32 v[148:149], v[148:149], s[70:71], v[186:187] op_sel_hi:[1,1,0]
    v_pk_fma_f32 v[150:151], v[150:151], s[70:71], v[186:187] op_sel_hi:[1,1,0]
    v_pk_fma_f32 v[152:153], v[152:153], s[70:71], v[186:187] op_sel_hi:[1,1,0]
    v_pk_fma_f32 v[154:155], v[154:155], s[70:71], v[186:187] op_sel_hi:[1,1,0]
    v_pk_fma_f32 v[156:157], v[156:157], s[70:71], v[186:187] op_sel_hi:[1,1,0]
    v_pk_fma_f32 v[158:159], v[158:159], s[70:71], v[186:187] op_sel_hi:[1,1,0]
    v_pk_fma_f32 v[160:161], v[160:161], s[70:71], v[186:187] op_sel_hi:[1,1,0]
    v_pk_fma_f32 v[162:163], v[162:163], s[70:71], v[186:187] op_sel_hi:[1,1,0]
    v_exp_f32 v148, v148
    v_exp_f32 v149, v149
    v_exp_f32 v150, v150
    v_exp_f32 v151, v151
    v_exp_f32 v152, v152
    v_exp_f32 v153, v153
    v_exp_f32 v154, v154
    v_exp_f32 v155, v155
    v_exp_f32 v156, v156
    v_exp_f32 v157, v157
    v_exp_f32 v158, v158
    v_exp_f32 v159, v159
    v_exp_f32 v160, v160
    v_exp_f32 v161, v161
    v_exp_f32 v162, v162
    v_exp_f32 v163, v163
    v_pk_add_f32 v[186:187], v[148:149], v[150:151]
    v_pk_add_f32 v[188:189], v[152:153], v[154:155]
    v_pk_add_f32 v[186:187], v[186:187], v[156:157]
    v_pk_add_f32 v[188:189], v[188:189], v[158:159]
    v_pk_add_f32 v[186:187], v[186:187], v[160:161]
    v_pk_add_f32 v[188:189], v[188:189], v[162:163]
    v_pk_add_f32 v[186:187], v[186:187], v[188:189]
    v_add_f32_e64 v186, v186, v187
    v_rcp_f32 v186, v186
    s_nop 0
    v_pk_mul_f32 v[148:149], v[148:149], v[186:187] op_sel_hi:[1,0]
    v_pk_mul_f32 v[150:151], v[150:151], v[186:187] op_sel_hi:[1,0]
    v_pk_mul_f32 v[152:153], v[152:153], v[186:187] op_sel_hi:[1,0]
    v_pk_mul_f32 v[154:155], v[154:155], v[186:187] op_sel_hi:[1,0]
    v_pk_mul_f32 v[156:157], v[156:157], v[186:187] op_sel_hi:[1,0]
    v_pk_mul_f32 v[158:159], v[158:159], v[186:187] op_sel_hi:[1,0]
    v_pk_mul_f32 v[160:161], v[160:161], v[186:187] op_sel_hi:[1,0]
    v_pk_mul_f32 v[162:163], v[162:163], v[186:187] op_sel_hi:[1,0]
    v_cvt_pk_bf16_f32 v56, v148, v149
    v_cvt_pk_bf16_f32 v57, v150, v151
    v_cvt_pk_bf16_f32 v58, v152, v153
    v_cvt_pk_bf16_f32 v59, v154, v155
    v_cvt_pk_bf16_f32 v60, v156, v157
    v_cvt_pk_bf16_f32 v61, v158, v159
    v_cvt_pk_bf16_f32 v62, v160, v161
    v_cvt_pk_bf16_f32 v63, v162, v163
    ds_write_b128 v241, v[56:59] offset:24576
    ds_write_b128 v242, v[60:63] offset:24576
    s_waitcnt vmcnt(10)
    s_waitcnt lgkmcnt(0)
    s_barrier
    ds_read_b64_tr_b16 v[100:101], v238 offset:0
    ds_read_b64_tr_b16 v[104:105], v239
    v_add_u32 v239, v240, v239
    ds_read_b64_tr_b16 v[102:103], v238 offset:512
    ds_read_b64_tr_b16 v[106:107], v239
    v_add_u32 v239, v240, v239
    ds_read_b64_tr_b16 v[108:109], v238 offset:1024
    ds_read_b64_tr_b16 v[112:113], v239
    v_add_u32 v239, v240, v239
    ds_read_b64_tr_b16 v[110:111], v238 offset:1536
    ds_read_b64_tr_b16 v[114:115], v239
    v_add_u32 v239, v240, v239
    ds_read_b64_tr_b16 v[116:117], v238 offset:2048
    ds_read_b64_tr_b16 v[120:121], v239
    v_add_u32 v239, v240, v239
    ds_read_b64_tr_b16 v[118:119], v238 offset:2560
    ds_read_b64_tr_b16 v[122:123], v239
    v_add_u32 v239, v240, v239
    s_waitcnt lgkmcnt(8)
    v_mfma_f32_32x32x16_bf16 v[32:47], v[100:103], v[104:107], 0
    ds_read_b64_tr_b16 v[124:125], v238 offset:3072
    ds_read_b64_tr_b16 v[128:129], v239
    v_add_u32 v239, v240, v239
    ds_read_b64_tr_b16 v[126:127], v238 offset:3584
    ds_read_b64_tr_b16 v[130:131], v239
    v_add_u32 v239, v240, v239
    s_waitcnt lgkmcnt(8)
    v_mfma_f32_32x32x16_bf16 v[32:47], v[108:111], v[112:115], v[32:47]
    ds_read_b64_tr_b16 v[132:133], v238 offset:4096
    ds_read_b64_tr_b16 v[136:137], v239
    v_add_u32 v239, v240, v239
    ds_read_b64_tr_b16 v[134:135], v238 offset:4608
    ds_read_b64_tr_b16 v[138:139], v239
    v_add_u32 v239, v240, v239
    s_waitcnt lgkmcnt(8)
    v_mfma_f32_32x32x16_bf16 v[32:47], v[116:119], v[120:123], v[32:47]
    ds_read_b64_tr_b16 v[140:141], v238 offset:5120
    ds_read_b64_tr_b16 v[144:145], v239
    v_add_u32 v239, v240, v239
    ds_read_b64_tr_b16 v[142:143], v238 offset:5632
    ds_read_b64_tr_b16 v[146:147], v239
    v_add_u32 v239, v240, v239
    s_waitcnt lgkmcnt(8)
    v_mfma_f32_32x32x16_bf16 v[32:47], v[124:127], v[128:131], v[32:47]
    ds_read_b64_tr_b16 v[148:149], v238 offset:6144
    ds_read_b64_tr_b16 v[152:153], v239
    v_add_u32 v239, v240, v239
    ds_read_b64_tr_b16 v[150:151], v238 offset:6656
    ds_read_b64_tr_b16 v[154:155], v239
    v_add_u32 v239, v240, v239
    s_waitcnt lgkmcnt(8)
    v_mfma_f32_32x32x16_bf16 v[32:47], v[132:135], v[136:139], v[32:47]
    ds_read_b64_tr_b16 v[156:157], v238 offset:7168
    ds_read_b64_tr_b16 v[160:161], v239
    v_add_u32 v239, v240, v239
    ds_read_b64_tr_b16 v[158:159], v238 offset:7680
    ds_read_b64_tr_b16 v[162:163], v239
    v_add_u32 v239, v240, v239
    s_waitcnt lgkmcnt(8)
    v_mfma_f32_32x32x16_bf16 v[32:47], v[140:143], v[144:147], v[32:47]
    s_waitcnt lgkmcnt(4)
    v_mfma_f32_32x32x16_bf16 v[32:47], v[148:151], v[152:155], v[32:47]
    s_waitcnt lgkmcnt(0)
    v_mfma_f32_32x32x16_bf16 v[32:47], v[156:159], v[160:163], v[32:47]
    ds_read_b64_tr_b16 v[100:101], v198 offset:0
    ds_read_b64_tr_b16 v[102:103], v198 offset:256
    ds_read_b64_tr_b16 v[104:105], v198 offset:512
    ds_read_b64_tr_b16 v[106:107], v198 offset:768
    ds_read_b64_tr_b16 v[108:109], v198 offset:2048
    ds_read_b64_tr_b16 v[110:111], v198 offset:2304
    ds_read_b64_tr_b16 v[112:113], v198 offset:2560
    ds_read_b64_tr_b16 v[114:115], v198 offset:2816
    v_mov_b32 v83, s65
    v_mov_b32 v87, s65
    v_mov_b32 v91, s65
    v_mov_b32_e64 v90, 0
    v_cvt_pk_bf16_f32 v80, v32, v33
    v_cvt_pk_bf16_f32 v81, v34, v35
    v_cvt_pk_bf16_f32 v82, v36, v37
    buffer_store_dwordx4 v[80:83], v245, s[40:43], s76 offen offset:0 sc1
    v_cvt_pk_bf16_f32 v84, v38, v39
    v_cvt_pk_bf16_f32 v85, v40, v41
    v_cvt_pk_bf16_f32 v86, v42, v43
    buffer_store_dwordx4 v[84:87], v245, s[40:43], s76 offen offset:640 sc1
    v_cvt_pk_bf16_f32 v88, v44, v45
    v_cvt_pk_bf16_f32 v89, v46, v47
    buffer_store_dwordx4 v[88:91], v245, s[40:43], s76 offen offset:1280 sc1
    s_barrier
    s_waitcnt lgkmcnt(4)
    v_mfma_f32_32x32x16_bf16 v[0:15], v[100:103], a[120:123], 0
    ds_read_b64_tr_b16 v[116:117], v198 offset:4096
    ds_read_b64_tr_b16 v[118:119], v198 offset:4352
    s_add_u32 s48, s58, 81920
    s_add_u32 s49, s58, 81920
    s_add_u32 m0, s72, 65536
    v_mfma_f32_32x32x16_bf16 v[16:31], v[104:107], a[120:123], 0
    ds_read_b64_tr_b16 v[120:121], v198 offset:4608
    ds_read_b64_tr_b16 v[122:123], v198 offset:4864
    s_add_u32 s76, s0, 7680
    s_add_u32 s3, s0, 15360
    s_add_u32 s50, s0, 23040
    s_waitcnt lgkmcnt(4)
    v_mfma_f32_32x32x16_bf16 v[0:15], v[108:111], a[124:127], v[0:15]
    ds_read_b64_tr_b16 v[124:125], v198 offset:6144
    ds_read_b64_tr_b16 v[126:127], v198 offset:6400
    buffer_load_dwordx4 v164, s[32:35], s48 offen offset:0 lds
    s_waitcnt vmcnt(4)
    ds_read_b64_tr_b16 a[0:1], v216 offset:0
    v_mfma_f32_32x32x16_bf16 v[16:31], v[112:115], a[124:127], v[16:31]
    ds_read_b64_tr_b16 v[128:129], v198 offset:6656
    ds_read_b64_tr_b16 v[130:131], v198 offset:6912
    ds_read_b64_tr_b16 a[2:3], v216 offset:1024
    ds_read_b64_tr_b16 a[4:5], v217 offset:0
    v_mov_b32 v35, 0
    s_waitcnt lgkmcnt(7)
    v_mfma_f32_32x32x16_bf16 v[0:15], v[116:119], a[128:131], v[0:15]
    ds_read_b64_tr_b16 v[100:101], v198 offset:8192
    ds_read_b64_tr_b16 v[102:103], v198 offset:8448
    buffer_load_dwordx4 v165, s[32:35], s48 offen offset:1024 lds
    ds_read_b64_tr_b16 a[6:7], v217 offset:1024
    ds_read_b64_tr_b16 a[8:9], v216 offset:2048
    v_mfma_f32_32x32x16_bf16 v[16:31], v[120:123], a[128:131], v[16:31]
    ds_read_b64_tr_b16 v[104:105], v198 offset:8704
    ds_read_b64_tr_b16 v[106:107], v198 offset:8960
    ds_read_b64_tr_b16 a[10:11], v216 offset:3072
    ds_read_b64_tr_b16 a[12:13], v217 offset:2048
    v_mov_b32 v39, 0
    s_waitcnt lgkmcnt(10)
    v_mfma_f32_32x32x16_bf16 v[0:15], v[124:127], a[132:135], v[0:15]
    ds_read_b64_tr_b16 v[108:109], v198 offset:10240
    ds_read_b64_tr_b16 v[110:111], v198 offset:10496
    buffer_load_dwordx4 v166, s[32:35], s48 offen offset:2048 lds
    ds_read_b64_tr_b16 a[14:15], v217 offset:3072
    ds_read_b64_tr_b16 a[16:17], v216 offset:4096
    v_mfma_f32_32x32x16_bf16 v[16:31], v[128:131], a[132:135], v[16:31]
    ds_read_b64_tr_b16 v[112:113], v198 offset:10752
    ds_read_b64_tr_b16 v[114:115], v198 offset:11008
    ds_read_b64_tr_b16 a[18:19], v216 offset:5120
    ds_read_b64_tr_b16 a[20:21], v217 offset:4096
    v_mov_b32 v42, 0
    s_waitcnt lgkmcnt(10)
    v_mfma_f32_32x32x16_bf16 v[0:15], v[100:103], a[136:139], v[0:15]
    ds_read_b64_tr_b16 v[116:117], v198 offset:12288
    ds_read_b64_tr_b16 v[118:119], v198 offset:12544
    buffer_load_dwordx4 v167, s[32:35], s48 offen offset:3072 lds
    ds_read_b64_tr_b16 a[22:23], v217 offset:5120
    ds_read_b64_tr_b16 a[24:25], v216 offset:6144
    v_mfma_f32_32x32x16_bf16 v[16:31], v[104:107], a[136:139], v[16:31]
    ds_read_b64_tr_b16 v[120:121], v198 offset:12800
    ds_read_b64_tr_b16 v[122:123], v198 offset:13056
    s_add_u32 m0, m0, 4096
    ds_read_b64_tr_b16 a[26:27], v216 offset:7168
    ds_read_b64_tr_b16 a[28:29], v217 offset:6144
    s_waitcnt lgkmcnt(10)
    v_mfma_f32_32x32x16_bf16 v[0:15], v[108:111], a[140:143], v[0:15]
    ds_read_b64_tr_b16 v[124:125], v198 offset:14336
    ds_read_b64_tr_b16 v[126:127], v198 offset:14592
    buffer_load_dwordx4 v168, s[32:35], s49 offen offset:0 lds
    ds_read_b64_tr_b16 a[30:31], v217 offset:7168
    ds_read_b64_tr_b16 a[32:33], v216 offset:8192
    v_mfma_f32_32x32x16_bf16 v[16:31], v[112:115], a[140:143], v[16:31]
    ds_read_b64_tr_b16 v[128:129], v198 offset:14848
    ds_read_b64_tr_b16 v[130:131], v198 offset:15104
    ds_read_b64_tr_b16 a[34:35], v216 offset:9216
    ds_read_b64_tr_b16 a[36:37], v217 offset:8192
    v_mov_b32 v43, 0
    s_waitcnt lgkmcnt(10)
    v_mfma_f32_32x32x16_bf16 v[0:15], v[116:119], a[144:147], v[0:15]
    ds_read_b64_tr_b16 v[100:101], v198 offset:16384
    ds_read_b64_tr_b16 v[102:103], v198 offset:16640
    buffer_load_dwordx4 v169, s[32:35], s49 offen offset:1024 lds
    ds_read_b64_tr_b16 a[38:39], v217 offset:9216
    v_mov_b32 v47, 0
    v_mfma_f32_32x32x16_bf16 v[16:31], v[120:123], a[144:147], v[16:31]
    ds_read_b64_tr_b16 v[104:105], v198 offset:16896
    ds_read_b64_tr_b16 v[106:107], v198 offset:17152
    v_mov_b32 v51, 0
    v_mov_b32 v54, 0
    v_mov_b32 v55, 0
    s_waitcnt lgkmcnt(7)
    v_mfma_f32_32x32x16_bf16 v[0:15], v[124:127], a[148:151], v[0:15]
    ds_read_b64_tr_b16 v[108:109], v198 offset:18432
    ds_read_b64_tr_b16 v[110:111], v198 offset:18688
    buffer_load_dwordx4 v170, s[32:35], s49 offen offset:2048 lds
    v_mov_b32 v59, 0
    v_mov_b32 v63, 0
    v_mfma_f32_32x32x16_bf16 v[16:31], v[128:131], a[148:151], v[16:31]
    ds_read_b64_tr_b16 v[112:113], v198 offset:18944
    ds_read_b64_tr_b16 v[114:115], v198 offset:19200
    v_mov_b32 v66, 0
    v_mov_b32 v67, 0
    v_mov_b32 v71, 0
    s_waitcnt lgkmcnt(4)
    v_mfma_f32_32x32x16_bf16 v[0:15], v[100:103], a[152:155], v[0:15]
    ds_read_b64_tr_b16 v[116:117], v198 offset:20480
    ds_read_b64_tr_b16 v[118:119], v198 offset:20736
    buffer_load_dwordx4 v171, s[32:35], s49 offen offset:3072 lds
    v_mov_b32 v75, 0
    v_mov_b32 v78, 0
    v_mfma_f32_32x32x16_bf16 v[16:31], v[104:107], a[152:155], v[16:31]
    ds_read_b64_tr_b16 v[120:121], v198 offset:20992
    ds_read_b64_tr_b16 v[122:123], v198 offset:21248
    s_add_u32 m0, m0, 4096
    v_mov_b32 v79, 0
    s_lshr_b32 s61, s52, 1
    s_waitcnt lgkmcnt(4)
    v_mfma_f32_32x32x16_bf16 v[0:15], v[108:111], a[156:159], v[0:15]
    ds_read_b64_tr_b16 v[124:125], v198 offset:22528
    ds_read_b64_tr_b16 v[126:127], v198 offset:22784
    buffer_load_dwordx4 v172, s[32:35], s49 offen offset:0 lds
    s_lshl_b32 s62, s56, 1
    s_add_u32 s62, s62, s61
    v_mfma_f32_32x32x16_bf16 v[16:31], v[112:115], a[156:159], v[16:31]
    ds_read_b64_tr_b16 v[128:129], v198 offset:23040
    ds_read_b64_tr_b16 v[130:131], v198 offset:23296
    s_mul_i32 s63, s62, 122880
    v_add_u32 v222, s63, v180
    s_xor_b32 s63, s62, 1
    s_waitcnt lgkmcnt(4)
    v_mfma_f32_32x32x16_bf16 v[0:15], v[116:119], a[160:163], v[0:15]
    ds_read_b64_tr_b16 v[100:101], v198 offset:24576
    ds_read_b64_tr_b16 v[102:103], v198 offset:24832
    buffer_load_dwordx4 v173, s[32:35], s49 offen offset:1024 lds
    s_mul_i32 s63, s63, 122880
    v_add_u32 v223, s63, v180
    v_mfma_f32_32x32x16_bf16 v[16:31], v[120:123], a[160:163], v[16:31]
    ds_read_b64_tr_b16 v[104:105], v198 offset:25088
    ds_read_b64_tr_b16 v[106:107], v198 offset:25344
    s_lshl_b32 s62, s62, 15
    s_lshl_b32 s63, s57, 7
    s_add_u32 s62, s62, s63
    s_waitcnt lgkmcnt(4)
    v_mfma_f32_32x32x16_bf16 v[0:15], v[124:127], a[164:167], v[0:15]
    ds_read_b64_tr_b16 v[108:109], v198 offset:26624
    ds_read_b64_tr_b16 v[110:111], v198 offset:26880
    s_and_b32 s63, s52, 1
    s_lshl_b32 s63, s63, 6
    s_add_u32 s62, s62, s63
    v_mfma_f32_32x32x16_bf16 v[16:31], v[128:131], a[164:167], v[16:31]
    ds_read_b64_tr_b16 v[112:113], v198 offset:27136
    ds_read_b64_tr_b16 v[114:115], v198 offset:27392
    v_lshlrev_b32 v186, 10, v233
    v_lshl_add_u32 v186, v232, 4, v186
    v_add_u32 v224, s62, v186
    buffer_load_dwordx4 v[132:135], v252, s[40:43], s0 offen sc1
    buffer_load_dwordx4 v[136:139], v252, s[40:43], s76 offen sc1
    buffer_load_dwordx4 v[140:143], v252, s[40:43], s3 offen sc1
    buffer_load_dwordx4 v[144:147], v252, s[40:43], s50 offen sc1
    s_waitcnt lgkmcnt(4)
    v_mfma_f32_32x32x16_bf16 v[0:15], v[100:103], a[168:171], v[0:15]
    ds_read_b64_tr_b16 v[116:117], v198 offset:28672
    ds_read_b64_tr_b16 v[118:119], v198 offset:28928
    v_lshlrev_b32 v186, 2, v233
    v_lshl_or_b32 v226, v232, 30, v186
    s_lshr_b32 s61, s56, 1
    v_mfma_f32_32x32x16_bf16 v[16:31], v[104:107], a[168:171], v[16:31]
    ds_read_b64_tr_b16 v[120:121], v198 offset:29184
    ds_read_b64_tr_b16 v[122:123], v198 offset:29440
    s_lshl_b32 s61, s61, 3
    s_add_u32 s61, s61, s52
    s_lshl_b32 s61, s61, 2
    s_waitcnt lgkmcnt(4)
    v_mfma_f32_32x32x16_bf16 v[0:15], v[108:111], a[172:175], v[0:15]
    ds_read_b64_tr_b16 v[124:125], v198 offset:30720
    ds_read_b64_tr_b16 v[126:127], v198 offset:30976
    s_add_u32 s48, s59, 245760
    s_add_u32 s49, s59, 245760
    s_add_u32 m0, s72, 114688
    v_mfma_f32_32x32x16_bf16 v[16:31], v[112:115], a[172:175], v[16:31]
    ds_read_b64_tr_b16 v[128:129], v198 offset:31232
    ds_read_b64_tr_b16 v[130:131], v198 offset:31488
    s_and_b32 s62, s56, 1
    s_add_u32 s61, s61, s62
    s_lshl_b32 s61, s61, 8
    s_waitcnt lgkmcnt(4)
    v_mfma_f32_32x32x16_bf16 v[0:15], v[116:119], a[176:179], v[0:15]
    ds_read_b64_tr_b16 v[100:101], v198 offset:32768
    ds_read_b64_tr_b16 v[102:103], v198 offset:33024
    buffer_load_dwordx4 v164, s[32:35], s48 offen offset:0 lds
    s_add_u32 s74, s61, 9437184
    s_xor_b32 s62, s52, 0
    v_mfma_f32_32x32x16_bf16 v[16:31], v[120:123], a[176:179], v[16:31]
    ds_read_b64_tr_b16 v[104:105], v198 offset:33280
    ds_read_b64_tr_b16 v[106:107], v198 offset:33536
    s_mul_i32 s62, s62, 10240
    s_add_u32 s62, s62, 65536
    v_add_u32 v227, s62, v180
    s_waitcnt lgkmcnt(4)
    v_mfma_f32_32x32x16_bf16 v[0:15], v[124:127], a[180:183], v[0:15]
    ds_read_b64_tr_b16 v[108:109], v198 offset:34816
    ds_read_b64_tr_b16 v[110:111], v198 offset:35072
    buffer_load_dwordx4 v165, s[32:35], s48 offen offset:1024 lds
    s_xor_b32 s62, s52, 0
    s_mul_i32 s62, s62, 10240
    v_mfma_f32_32x32x16_bf16 v[16:31], v[128:131], a[180:183], v[16:31]
    ds_read_b64_tr_b16 v[112:113], v198 offset:35328
    ds_read_b64_tr_b16 v[114:115], v198 offset:35584
    s_add_u32 s62, s62, 0
    v_add_u32 v228, s62, v180
    s_xor_b32 s62, s52, 1
    s_waitcnt lgkmcnt(4)
    v_mfma_f32_32x32x16_bf16 v[0:15], v[100:103], a[184:187], v[0:15]
    ds_read_b64_tr_b16 v[116:117], v198 offset:36864
    ds_read_b64_tr_b16 v[118:119], v198 offset:37120
    buffer_load_dwordx4 v166, s[32:35], s48 offen offset:2048 lds
    s_mul_i32 s62, s62, 10240
    s_add_u32 s62, s62, 65536
    v_mfma_f32_32x32x16_bf16 v[16:31], v[104:107], a[184:187], v[16:31]
    ds_read_b64_tr_b16 v[120:121], v198 offset:37376
    ds_read_b64_tr_b16 v[122:123], v198 offset:37632
    v_add_u32 v229, s62, v180
    s_xor_b32 s62, s52, 2
    s_mul_i32 s62, s62, 10240
    s_waitcnt lgkmcnt(4)
    v_mfma_f32_32x32x16_bf16 v[0:15], v[108:111], a[188:191], v[0:15]
    ds_read_b64_tr_b16 v[124:125], v198 offset:38912
    ds_read_b64_tr_b16 v[126:127], v198 offset:39168
    buffer_load_dwordx4 v167, s[32:35], s48 offen offset:3072 lds
    s_waitcnt vmcnt(8)
    ds_read_b64_tr_b16 a[40:41], v218 offset:0
    v_mfma_f32_32x32x16_bf16 v[16:31], v[112:115], a[188:191], v[16:31]
    ds_read_b64_tr_b16 v[128:129], v198 offset:39424
    ds_read_b64_tr_b16 v[130:131], v198 offset:39680
    s_add_u32 m0, m0, 4096
    ds_read_b64_tr_b16 a[42:43], v218 offset:1024
    ds_read_b64_tr_b16 a[44:45], v219 offset:0
    s_waitcnt lgkmcnt(7)
    v_mfma_f32_32x32x16_bf16 v[0:15], v[116:119], a[192:195], v[0:15]
    ds_read_b64_tr_b16 v[100:101], v198 offset:40960
    ds_read_b64_tr_b16 v[102:103], v198 offset:41216
    buffer_load_dwordx4 v168, s[32:35], s49 offen offset:0 lds
    ds_read_b64_tr_b16 a[46:47], v219 offset:1024
    ds_read_b64_tr_b16 a[48:49], v218 offset:2048
    v_mfma_f32_32x32x16_bf16 v[16:31], v[120:123], a[192:195], v[16:31]
    ds_read_b64_tr_b16 v[104:105], v198 offset:41472
    ds_read_b64_tr_b16 v[106:107], v198 offset:41728
    ds_read_b64_tr_b16 a[50:51], v218 offset:3072
    ds_read_b64_tr_b16 a[52:53], v219 offset:2048
    s_add_u32 s62, s62, 69632
    s_waitcnt lgkmcnt(10)
    v_mfma_f32_32x32x16_bf16 v[0:15], v[124:127], a[196:199], v[0:15]
    ds_read_b64_tr_b16 v[108:109], v198 offset:43008
    ds_read_b64_tr_b16 v[110:111], v198 offset:43264
    buffer_load_dwordx4 v169, s[32:35], s49 offen offset:1024 lds
    ds_read_b64_tr_b16 a[54:55], v219 offset:3072
    ds_read_b64_tr_b16 a[56:57], v218 offset:4096
    v_mfma_f32_32x32x16_bf16 v[16:31], v[128:131], a[196:199], v[16:31]
    ds_read_b64_tr_b16 v[112:113], v198 offset:43520
    ds_read_b64_tr_b16 v[114:115], v198 offset:43776
    ds_read_b64_tr_b16 a[58:59], v218 offset:5120
    ds_read_b64_tr_b16 a[60:61], v219 offset:4096
    v_add_u32 v230, s62, v180
    s_waitcnt lgkmcnt(10)
    v_mfma_f32_32x32x16_bf16 v[0:15], v[100:103], a[200:203], v[0:15]
    ds_read_b64_tr_b16 v[116:117], v198 offset:45056
    ds_read_b64_tr_b16 v[118:119], v198 offset:45312
    buffer_load_dwordx4 v170, s[32:35], s49 offen offset:2048 lds
    ds_read_b64_tr_b16 a[62:63], v219 offset:5120
    ds_read_b64_tr_b16 a[64:65], v218 offset:6144
    v_mfma_f32_32x32x16_bf16 v[16:31], v[104:107], a[200:203], v[16:31]
    ds_read_b64_tr_b16 v[120:121], v198 offset:45568
    ds_read_b64_tr_b16 v[122:123], v198 offset:45824
    ds_read_b64_tr_b16 a[66:67], v218 offset:7168
    ds_read_b64_tr_b16 a[68:69], v219 offset:6144
    s_xor_b32 s62, s52, 3
    s_waitcnt lgkmcnt(10)
    v_mfma_f32_32x32x16_bf16 v[0:15], v[108:111], a[204:207], v[0:15]
    ds_read_b64_tr_b16 v[124:125], v198 offset:47104
    ds_read_b64_tr_b16 v[126:127], v198 offset:47360
    buffer_load_dwordx4 v171, s[32:35], s49 offen offset:3072 lds
    ds_read_b64_tr_b16 a[70:71], v219 offset:7168
    ds_read_b64_tr_b16 a[72:73], v218 offset:8192
    v_mfma_f32_32x32x16_bf16 v[16:31], v[112:115], a[204:207], v[16:31]
    ds_read_b64_tr_b16 v[128:129], v198 offset:47616
    ds_read_b64_tr_b16 v[130:131], v198 offset:47872
    s_add_u32 m0, m0, 4096
    ds_read_b64_tr_b16 a[74:75], v218 offset:9216
    ds_read_b64_tr_b16 a[76:77], v219 offset:8192
    s_waitcnt lgkmcnt(10)
    v_mfma_f32_32x32x16_bf16 v[0:15], v[116:119], a[208:211], v[0:15]
    ds_read_b64_tr_b16 v[100:101], v198 offset:49152
    ds_read_b64_tr_b16 v[102:103], v198 offset:49408
    buffer_load_dwordx4 v172, s[32:35], s49 offen offset:0 lds
    ds_read_b64_tr_b16 a[78:79], v219 offset:9216
    s_mul_i32 s62, s62, 10240
    v_mfma_f32_32x32x16_bf16 v[16:31], v[120:123], a[208:211], v[16:31]
    ds_read_b64_tr_b16 v[104:105], v198 offset:49664
    ds_read_b64_tr_b16 v[106:107], v198 offset:49920
    s_add_u32 s62, s62, 0
    v_add_u32 v231, s62, v180
    v_lshlrev_b32 v186, 1, v233
    s_waitcnt lgkmcnt(7)
    v_mfma_f32_32x32x16_bf16 v[0:15], v[124:127], a[212:215], v[0:15]
    ds_read_b64_tr_b16 v[108:109], v198 offset:51200
    ds_read_b64_tr_b16 v[110:111], v198 offset:51456
    buffer_load_dwordx4 v173, s[32:35], s49 offen offset:1024 lds
    v_lshl_add_u32 v186, v232, 30, v186
    s_lshl_b32 s61, s57, 7
    v_mfma_f32_32x32x16_bf16 v[16:31], v[128:131], a[212:215], v[16:31]
    ds_read_b64_tr_b16 v[112:113], v198 offset:51712
    ds_read_b64_tr_b16 v[114:115], v198 offset:51968
    s_cmp_eq_u32 s52, 3
    s_cselect_b32 s61, s61, 1073741824
    s_cmp_lt_u32 s53, 8
    s_waitcnt vmcnt(10)
    s_cbranch_scc0 L_nred
    v_cmp_ne_u32 vcc, s65, v135
    s_cbranch_vccnz L_red_r
    v_cmp_ne_u32 vcc, s65, v139
    s_cbranch_vccnz L_red_r
    v_cmp_ne_u32 vcc, s65, v143
    s_cbranch_vccnz L_red_r
    v_cmp_ne_u32 vcc, s65, v147
    s_cbranch_vccnz L_red_r
L_red_ok:
    v_mfma_f32_16x16x32_bf16 v[148:151], v[248:251], v[132:135], 0
    v_mfma_f32_16x16x32_bf16 v[148:151], v[248:251], v[136:139], v[148:151]
    v_mfma_f32_16x16x32_bf16 v[148:151], v[248:251], v[140:143], v[148:151]
    v_mfma_f32_16x16x32_bf16 v[148:151], v[248:251], v[144:147], v[148:151]
    v_mov_b32 v155, s65
    s_nop 6
    v_cvt_pk_bf16_f32 v152, v148, v149
    v_cvt_pk_bf16_f32 v156, v148, v149
    v_cvt_pk_bf16_f32 v153, v150, v151
    s_nop 0
    v_permlane16_swap_b32 v156, v154
    buffer_store_dwordx4 v[152:155], v253, s[40:43], s77 offen sc1
L_nred:
    s_waitcnt lgkmcnt(4)
    v_mfma_f32_32x32x16_bf16 v[0:15], v[100:103], a[216:219], v[0:15]
    ds_read_b64_tr_b16 v[116:117], v198 offset:53248
    ds_read_b64_tr_b16 v[118:119], v198 offset:53504
    s_add_u32 s48, s59, 327680
    s_lshl_b32 s49, s52, 17
    s_add_u32 m0, s72, 65536
    v_mfma_f32_32x32x16_bf16 v[16:31], v[104:107], a[216:219], v[16:31]
    ds_read_b64_tr_b16 v[120:121], v198 offset:53760
    ds_read_b64_tr_b16 v[122:123], v198 offset:54016
    s_mov_b32 s44, s20
    s_mov_b32 s45, s21
    s_mov_b32 s46, 1024
    s_mov_b32 s47, 0x20000
    buffer_load_ushort v234, v186, s[44:47], s61 offen offset:64
    buffer_load_ushort v235, v186, s[44:47], s61 offen
    s_waitcnt lgkmcnt(4)
    v_mfma_f32_32x32x16_bf16 v[0:15], v[108:111], a[220:223], v[0:15]
    ds_read_b64_tr_b16 v[124:125], v198 offset:55296
    ds_read_b64_tr_b16 v[126:127], v198 offset:55552
    buffer_load_dwordx4 v164, s[32:35], s48 offen offset:0 lds
    s_mul_i32 s61, s52, 1920
    s_add_u32 s61, s61, 106496
    v_mfma_f32_32x32x16_bf16 v[16:31], v[112:115], a[220:223], v[16:31]
    ds_read_b64_tr_b16 v[128:129], v198 offset:55808
    ds_read_b64_tr_b16 v[130:131], v198 offset:56064
    v_add_u32 v194, s61, v180
    v_add_u32_e64 v195, s61, v246
    s_add_u32 s64, s74, 4096
    s_waitcnt lgkmcnt(4)
    v_mfma_f32_32x32x16_bf16 v[0:15], v[116:119], a[224:227], v[0:15]
    ds_read_b64_tr_b16 v[100:101], v198 offset:57344
    ds_read_b64_tr_b16 v[102:103], v198 offset:57600
    buffer_load_dwordx4 v165, s[32:35], s48 offen offset:1024 lds
    s_add_u32 s66, s72, 114688
    v_mfma_f32_32x32x16_bf16 v[16:31], v[120:123], a[224:227], v[16:31]
    ds_read_b64_tr_b16 v[104:105], v198 offset:57856
    ds_read_b64_tr_b16 v[106:107], v198 offset:58112
    s_waitcnt lgkmcnt(4)
    v_mfma_f32_32x32x16_bf16 v[0:15], v[124:127], a[228:231], v[0:15]
    ds_read_b64_tr_b16 v[108:109], v198 offset:59392
    ds_read_b64_tr_b16 v[110:111], v198 offset:59648
    buffer_load_dwordx4 v166, s[32:35], s48 offen offset:2048 lds
    v_mfma_f32_32x32x16_bf16 v[16:31], v[128:131], a[228:231], v[16:31]
    ds_read_b64_tr_b16 v[112:113], v198 offset:59904
    ds_read_b64_tr_b16 v[114:115], v198 offset:60160
    s_waitcnt lgkmcnt(4)
    v_mfma_f32_32x32x16_bf16 v[0:15], v[100:103], a[232:235], v[0:15]
    ds_read_b64_tr_b16 v[116:117], v198 offset:61440
    ds_read_b64_tr_b16 v[118:119], v198 offset:61696
    buffer_load_dwordx4 v167, s[32:35], s48 offen offset:3072 lds
    v_mfma_f32_32x32x16_bf16 v[16:31], v[104:107], a[232:235], v[16:31]
    ds_read_b64_tr_b16 v[120:121], v198 offset:61952
    ds_read_b64_tr_b16 v[122:123], v198 offset:62208
    s_add_u32 m0, m0, 4096
    s_waitcnt lgkmcnt(4)
    v_mfma_f32_32x32x16_bf16 v[0:15], v[108:111], a[236:239], v[0:15]
    ds_read_b64_tr_b16 v[124:125], v198 offset:63488
    ds_read_b64_tr_b16 v[126:127], v198 offset:63744
    buffer_load_dwordx4 v168, s[36:39], s49 offen offset:0 lds
    v_mfma_f32_32x32x16_bf16 v[16:31], v[112:115], a[236:239], v[16:31]
    ds_read_b64_tr_b16 v[128:129], v198 offset:64000
    ds_read_b64_tr_b16 v[130:131], v198 offset:64256
    s_waitcnt lgkmcnt(4)
    v_mfma_f32_32x32x16_bf16 v[0:15], v[116:119], a[240:243], v[0:15]
    buffer_load_dwordx4 v169, s[36:39], s49 offen offset:1024 lds
    v_mfma_f32_32x32x16_bf16 v[16:31], v[120:123], a[240:243], v[16:31]
    s_waitcnt lgkmcnt(0)
    v_mfma_f32_32x32x16_bf16 v[0:15], v[124:127], a[244:247], v[0:15]
    buffer_load_dwordx4 v170, s[36:39], s49 offen offset:2048 lds
    v_mfma_f32_32x32x16_bf16 v[16:31], v[128:131], a[244:247], v[16:31]
    s_barrier
    buffer_load_dwordx4 v171, s[36:39], s49 offen offset:3072 lds
    s_add_u32 m0, m0, 4096
    s_nop 0
    buffer_load_dwordx4 v172, s[36:39], s49 offen offset:0 lds
    buffer_load_dwordx4 v173, s[36:39], s49 offen offset:1024 lds
    s_nop 7
    s_nop 3
    v_cvt_pk_bf16_f32 v0, v0, v1
    v_cvt_pk_bf16_f32 v1, v2, v3
    v_cvt_pk_bf16_f32 v2, v4, v5
    v_cvt_pk_bf16_f32 v3, v6, v7
    v_cvt_pk_bf16_f32 v8, v8, v9
    v_cvt_pk_bf16_f32 v9, v10, v11
    v_cvt_pk_bf16_f32 v10, v12, v13
    v_cvt_pk_bf16_f32 v11, v14, v15
    v_mfma_f32_32x32x16_bf16 v[100:115], v[200:203], v[0:3], 0
    v_cvt_pk_bf16_f32 v16, v16, v17
    v_cvt_pk_bf16_f32 v17, v18, v19
    v_cvt_pk_bf16_f32 v18, v20, v21
    v_cvt_pk_bf16_f32 v19, v22, v23
    v_mfma_f32_32x32x16_bf16 v[116:131], v[204:207], v[8:11], 0
    v_cvt_pk_bf16_f32 v24, v24, v25
    v_cvt_pk_bf16_f32 v25, v26, v27
    v_cvt_pk_bf16_f32 v26, v28, v29
    v_cvt_pk_bf16_f32 v27, v30, v31
    v_mfma_f32_32x32x16_bf16 v[132:147], v[208:211], v[16:19], 0
    s_nop 0
    v_mfma_f32_32x32x16_bf16 v[148:163], v[212:215], v[24:27], 0
    s_nop 0
    v_max3_f32 v188, v100, v101, v102
    v_max3_f32 v189, v103, v104, v105
    v_max3_f32 v188, v188, v106, v107
    v_max3_f32 v189, v189, v108, v109
    v_max3_f32 v188, v188, v110, v111
    v_max3_f32 v189, v189, v112, v113
    v_max3_f32 v188, v188, v114, v115
    s_mov_b32 s48, s60
    s_nop 0
    v_max_f32_e64 v188, v188, v189
    v_mul_f32 v188, 0xbfb8aa3b, v188
    v_pk_fma_f32 v[100:101], v[100:101], s[70:71], v[188:189] op_sel_hi:[1,1,0]
    v_pk_fma_f32 v[102:103], v[102:103], s[70:71], v[188:189] op_sel_hi:[1,1,0]
    v_pk_fma_f32 v[104:105], v[104:105], s[70:71], v[188:189] op_sel_hi:[1,1,0]
    v_pk_fma_f32 v[106:107], v[106:107], s[70:71], v[188:189] op_sel_hi:[1,1,0]
    v_pk_fma_f32 v[108:109], v[108:109], s[70:71], v[188:189] op_sel_hi:[1,1,0]
    s_add_u32 s49, s59, 163840
    v_pk_fma_f32 v[110:111], v[110:111], s[70:71], v[188:189] op_sel_hi:[1,1,0]
    v_pk_fma_f32 v[112:113], v[112:113], s[70:71], v[188:189] op_sel_hi:[1,1,0]
    v_pk_fma_f32 v[114:115], v[114:115], s[70:71], v[188:189] op_sel_hi:[1,1,0]
    v_exp_f32 v100, v100
    v_exp_f32 v101, v101
    v_exp_f32 v102, v102
    v_exp_f32 v103, v103
    s_add_u32 m0, s72, 0
    v_exp_f32 v104, v104
    v_exp_f32 v105, v105
    v_exp_f32 v106, v106
    v_exp_f32 v107, v107
    v_exp_f32 v108, v108
    v_exp_f32 v109, v109
    v_exp_f32 v110, v110
    buffer_load_dwordx4 v164, s[32:35], s48 offen offset:0 lds
    v_exp_f32 v111, v111
    v_exp_f32 v112, v112
    v_exp_f32 v113, v113
    v_exp_f32 v114, v114
    v_exp_f32_e64 v115, v115
    v_pk_add_f32 v[188:189], v[100:101], v[102:103]
    v_pk_add_f32 v[190:191], v[104:105], v[106:107]
    buffer_load_dwordx4 v165, s[32:35], s48 offen offset:1024 lds
    v_pk_add_f32 v[188:189], v[188:189], v[108:109]
    v_pk_add_f32 v[190:191], v[190:191], v[110:111]
    v_pk_add_f32 v[188:189], v[188:189], v[112:113]
    v_pk_add_f32 v[190:191], v[190:191], v[114:115]
    v_pk_add_f32 v[188:189], v[188:189], v[190:191]
    v_add_f32_e64 v188, v188, v189
    v_rcp_f32 v188, v188
    buffer_load_dwordx4 v166, s[32:35], s48 offen offset:2048 lds
    s_nop 0
    v_pk_mul_f32 v[100:101], v[100:101], v[188:189] op_sel_hi:[1,0]
    v_pk_mul_f32 v[102:103], v[102:103], v[188:189] op_sel_hi:[1,0]
    v_pk_mul_f32 v[104:105], v[104:105], v[188:189] op_sel_hi:[1,0]
    v_pk_mul_f32 v[106:107], v[106:107], v[188:189] op_sel_hi:[1,0]
    v_pk_mul_f32 v[108:109], v[108:109], v[188:189] op_sel_hi:[1,0]
    v_pk_mul_f32 v[110:111], v[110:111], v[188:189] op_sel_hi:[1,0]
    buffer_load_dwordx4 v167, s[32:35], s48 offen offset:3072 lds
    v_pk_mul_f32 v[112:113], v[112:113], v[188:189] op_sel_hi:[1,0]
    v_pk_mul_f32 v[114:115], v[114:115], v[188:189] op_sel_hi:[1,0]
    v_cvt_pk_bf16_f32 v32, v100, v101
    v_cvt_pk_bf16_f32 v33, v102, v103
    v_cvt_pk_bf16_f32 v34, v104, v105
    v_cvt_pk_bf16_f32 v36, v106, v107
    v_cvt_pk_bf16_f32 v37, v108, v109
    s_add_u32 m0, m0, 4096
    v_cvt_pk_bf16_f32 v38, v110, v111
    v_cvt_pk_bf16_f32 v40, v112, v113
    v_cvt_pk_bf16_f32 v41, v114, v115
    v_max3_f32 v188, v116, v117, v118
    v_max3_f32 v189, v119, v120, v121
    v_max3_f32 v188, v188, v122, v123
    v_max3_f32 v189, v189, v124, v125
    v_max3_f32 v188, v188, v126, v127
    v_max3_f32 v189, v189, v128, v129
    v_max3_f32 v188, v188, v130, v131
    buffer_load_dwordx4 v168, s[32:35], s49 offen offset:0 lds
    v_max_f32_e64 v188, v188, v189
    v_mul_f32 v188, 0xbfb8aa3b, v188
    v_pk_fma_f32 v[116:117], v[116:117], s[70:71], v[188:189] op_sel_hi:[1,1,0]
    v_pk_fma_f32 v[118:119], v[118:119], s[70:71], v[188:189] op_sel_hi:[1,1,0]
    v_pk_fma_f32 v[120:121], v[120:121], s[70:71], v[188:189] op_sel_hi:[1,1,0]
    v_pk_fma_f32 v[122:123], v[122:123], s[70:71], v[188:189] op_sel_hi:[1,1,0]
    v_pk_fma_f32 v[124:125], v[124:125], s[70:71], v[188:189] op_sel_hi:[1,1,0]
    buffer_load_dwordx4 v169, s[32:35], s49 offen offset:1024 lds
    v_pk_fma_f32 v[126:127], v[126:127], s[70:71], v[188:189] op_sel_hi:[1,1,0]
    v_pk_fma_f32 v[128:129], v[128:129], s[70:71], v[188:189] op_sel_hi:[1,1,0]
    v_pk_fma_f32 v[130:131], v[130:131], s[70:71], v[188:189] op_sel_hi:[1,1,0]
    v_exp_f32 v116, v116
    v_exp_f32 v117, v117
    v_exp_f32 v118, v118
    v_exp_f32 v119, v119
    buffer_load_dwordx4 v170, s[32:35], s49 offen offset:2048 lds
    v_exp_f32 v120, v120
    v_exp_f32 v121, v121
    v_exp_f32 v122, v122
    v_exp_f32 v123, v123
    v_exp_f32 v124, v124
    v_exp_f32 v125, v125
    v_exp_f32 v126, v126
    buffer_load_dwordx4 v171, s[32:35], s49 offen offset:3072 lds
    v_exp_f32 v127, v127
    v_exp_f32 v128, v128
    v_exp_f32 v129, v129
    v_exp_f32 v130, v130
    v_exp_f32 v131, v131
    v_pk_add_f32 v[188:189], v[116:117], v[118:119]
    v_pk_add_f32 v[190:191], v[120:121], v[122:123]
    s_add_u32 m0, m0, 4096
    v_pk_add_f32 v[188:189], v[188:189], v[124:125]
    v_pk_add_f32 v[190:191], v[190:191], v[126:127]
    v_pk_add_f32 v[188:189], v[188:189], v[128:129]
    v_pk_add_f32 v[190:191], v[190:191], v[130:131]
    v_pk_add_f32 v[188:189], v[188:189], v[190:191]
    v_add_f32_e64 v188, v188, v189
    v_rcp_f32 v188, v188
    buffer_load_dwordx4 v172, s[32:35], s49 offen offset:0 lds
    s_nop 0
    v_pk_mul_f32 v[116:117], v[116:117], v[188:189] op_sel_hi:[1,0]
    v_pk_mul_f32 v[118:119], v[118:119], v[188:189] op_sel_hi:[1,0]
    v_pk_mul_f32 v[120:121], v[120:121], v[188:189] op_sel_hi:[1,0]
    v_pk_mul_f32 v[122:123], v[122:123], v[188:189] op_sel_hi:[1,0]
    v_pk_mul_f32 v[124:125], v[124:125], v[188:189] op_sel_hi:[1,0]
    v_pk_mul_f32 v[126:127], v[126:127], v[188:189] op_sel_hi:[1,0]
    buffer_load_dwordx4 v173, s[32:35], s49 offen offset:1024 lds
    v_pk_mul_f32 v[128:129], v[128:129], v[188:189] op_sel_hi:[1,0]
    v_pk_mul_f32 v[130:131], v[130:131], v[188:189] op_sel_hi:[1,0]
    v_cvt_pk_bf16_f32 v44, v116, v117
    v_cvt_pk_bf16_f32 v45, v118, v119
    v_cvt_pk_bf16_f32 v46, v120, v121
    v_cvt_pk_bf16_f32 v48, v122, v123
    v_cvt_pk_bf16_f32 v49, v124, v125
    v_cvt_pk_bf16_f32 v50, v126, v127
    v_cvt_pk_bf16_f32 v52, v128, v129
    v_cvt_pk_bf16_f32 v53, v130, v131
    v_max3_f32 v188, v132, v133, v134
    v_max3_f32 v189, v135, v136, v137
    v_max3_f32 v188, v188, v138, v139
    v_max3_f32 v189, v189, v140, v141
    v_max3_f32 v188, v188, v142, v143
    v_max3_f32 v189, v189, v144, v145
    v_max3_f32 v188, v188, v146, v147
    v_max_f32_e64 v188, v188, v189
    v_mul_f32 v188, 0xbfb8aa3b, v188
    v_pk_fma_f32 v[132:133], v[132:133], s[70:71], v[188:189] op_sel_hi:[1,1,0]
    v_pk_fma_f32 v[134:135], v[134:135], s[70:71], v[188:189] op_sel_hi:[1,1,0]
    v_pk_fma_f32 v[136:137], v[136:137], s[70:71], v[188:189] op_sel_hi:[1,1,0]
    v_pk_fma_f32 v[138:139], v[138:139], s[70:71], v[188:189] op_sel_hi:[1,1,0]
    v_pk_fma_f32 v[140:141], v[140:141], s[70:71], v[188:189] op_sel_hi:[1,1,0]
    v_pk_fma_f32 v[142:143], v[142:143], s[70:71], v[188:189] op_sel_hi:[1,1,0]
    v_pk_fma_f32 v[144:145], v[144:145], s[70:71], v[188:189] op_sel_hi:[1,1,0]
    v_pk_fma_f32 v[146:147], v[146:147], s[70:71], v[188:189] op_sel_hi:[1,1,0]
    v_exp_f32 v132, v132
    v_exp_f32 v133, v133
    v_exp_f32 v134, v134
    v_exp_f32 v135, v135
    v_exp_f32 v136, v136
    v_exp_f32 v137, v137
    v_exp_f32 v138, v138
    v_exp_f32 v139, v139
    v_exp_f32 v140, v140
    v_exp_f32 v141, v141
    v_exp_f32 v142, v142
    v_exp_f32 v143, v143
    v_exp_f32 v144, v144
    v_exp_f32 v145, v145
    v_exp_f32 v146, v146
    v_exp_f32 v147, v147
    v_pk_add_f32 v[188:189], v[132:133], v[134:135]
    v_pk_add_f32 v[190:191], v[136:137], v[138:139]
    v_pk_add_f32 v[188:189], v[188:189], v[140:141]
    v_pk_add_f32 v[190:191], v[190:191], v[142:143]
    v_pk_add_f32 v[188:189], v[188:189], v[144:145]
    v_pk_add_f32 v[190:191], v[190:191], v[146:147]
    v_pk_add_f32 v[188:189], v[188:189], v[190:191]
    v_add_f32_e64 v188, v188, v189
    v_rcp_f32 v188, v188
    s_nop 0
    v_pk_mul_f32 v[132:133], v[132:133], v[188:189] op_sel_hi:[1,0]
    v_pk_mul_f32 v[134:135], v[134:135], v[188:189] op_sel_hi:[1,0]
    v_pk_mul_f32 v[136:137], v[136:137], v[188:189] op_sel_hi:[1,0]
    v_pk_mul_f32 v[138:139], v[138:139], v[188:189] op_sel_hi:[1,0]
    v_pk_mul_f32 v[140:141], v[140:141], v[188:189] op_sel_hi:[1,0]
    v_pk_mul_f32 v[142:143], v[142:143], v[188:189] op_sel_hi:[1,0]
    v_pk_mul_f32 v[144:145], v[144:145], v[188:189] op_sel_hi:[1,0]
    v_pk_mul_f32 v[146:147], v[146:147], v[188:189] op_sel_hi:[1,0]
    v_cvt_pk_bf16_f32 v56, v132, v133
    v_cvt_pk_bf16_f32 v57, v134, v135
    v_cvt_pk_bf16_f32 v58, v136, v137
    v_cvt_pk_bf16_f32 v60, v138, v139
    v_cvt_pk_bf16_f32 v61, v140, v141
    v_cvt_pk_bf16_f32 v62, v142, v143
    v_cvt_pk_bf16_f32 v64, v144, v145
    v_cvt_pk_bf16_f32 v65, v146, v147
    buffer_load_dwordx4 v[80:83], v180, s[40:43], s77 offen sc1
    buffer_load_dwordx4 v[84:87], v246, s[40:43], s77 offen offset:1024 sc1
    buffer_load_dwordx2 v[182:183], v254, s[40:43], s1 offen sc1
    buffer_load_dword v186, v225, s[40:43], s64 offen sc1
    v_max3_f32 v188, v148, v149, v150
    v_max3_f32 v189, v151, v152, v153
    v_max3_f32 v188, v188, v154, v155
    v_max3_f32 v189, v189, v156, v157
    v_max3_f32 v188, v188, v158, v159
    v_max3_f32 v189, v189, v160, v161
    v_max3_f32 v188, v188, v162, v163
    v_max_f32_e64 v188, v188, v189
    v_mul_f32 v188, 0xbfb8aa3b, v188
    v_pk_fma_f32 v[148:149], v[148:149], s[70:71], v[188:189] op_sel_hi:[1,1,0]
    v_pk_fma_f32 v[150:151], v[150:151], s[70:71], v[188:189] op_sel_hi:[1,1,0]
    v_pk_fma_f32 v[152:153], v[152:153], s[70:71], v[188:189] op_sel_hi:[1,1,0]
    v_pk_fma_f32 v[154:155], v[154:155], s[70:71], v[188:189] op_sel_hi:[1,1,0]
    v_pk_fma_f32 v[156:157], v[156:157], s[70:71], v[188:189] op_sel_hi:[1,1,0]
    v_pk_fma_f32 v[158:159], v[158:159], s[70:71], v[188:189] op_sel_hi:[1,1,0]
    v_pk_fma_f32 v[160:161], v[160:161], s[70:71], v[188:189] op_sel_hi:[1,1,0]
    v_pk_fma_f32 v[162:163], v[162:163], s[70:71], v[188:189] op_sel_hi:[1,1,0]
    v_exp_f32 v148, v148
    v_exp_f32 v149, v149
    v_exp_f32 v150, v150
    v_exp_f32 v151, v151
    v_exp_f32 v152, v152
    v_exp_f32 v153, v153
    v_exp_f32 v154, v154
    v_exp_f32 v155, v155
    v_exp_f32 v156, v156
    v_exp_f32 v157, v157
    v_exp_f32 v158, v158
    v_exp_f32 v159, v159
    v_exp_f32 v160, v160
    v_exp_f32 v161, v161
    v_exp_f32 v162, v162
    v_exp_f32 v163, v163
    v_pk_add_f32 v[188:189], v[148:149], v[150:151]
    v_pk_add_f32 v[190:191], v[152:153], v[154:155]
    v_pk_add_f32 v[188:189], v[188:189], v[156:157]
    v_pk_add_f32 v[190:191], v[190:191], v[158:159]
    v_pk_add_f32 v[188:189], v[188:189], v[160:161]
    v_pk_add_f32 v[190:191], v[190:191], v[162:163]
    v_pk_add_f32 v[188:189], v[188:189], v[190:191]
    v_add_f32_e64 v188, v188, v189
    v_rcp_f32 v188, v188
    s_nop 0
    v_pk_mul_f32 v[148:149], v[148:149], v[188:189] op_sel_hi:[1,0]
    v_pk_mul_f32 v[150:151], v[150:151], v[188:189] op_sel_hi:[1,0]
    v_pk_mul_f32 v[152:153], v[152:153], v[188:189] op_sel_hi:[1,0]
    v_pk_mul_f32 v[154:155], v[154:155], v[188:189] op_sel_hi:[1,0]
    v_pk_mul_f32 v[156:157], v[156:157], v[188:189] op_sel_hi:[1,0]
    v_pk_mul_f32 v[158:159], v[158:159], v[188:189] op_sel_hi:[1,0]
    v_pk_mul_f32 v[160:161], v[160:161], v[188:189] op_sel_hi:[1,0]
    v_pk_mul_f32 v[162:163], v[162:163], v[188:189] op_sel_hi:[1,0]
    v_cvt_pk_bf16_f32 v68, v148, v149
    v_cvt_pk_bf16_f32 v69, v150, v151
    v_cvt_pk_bf16_f32 v70, v152, v153
    v_cvt_pk_bf16_f32 v72, v154, v155
    v_cvt_pk_bf16_f32 v73, v156, v157
    v_cvt_pk_bf16_f32 v74, v158, v159
    v_cvt_pk_bf16_f32 v76, v160, v161
    v_cvt_pk_bf16_f32 v77, v162, v163
    s_waitcnt vmcnt(0)
    v_cmp_ne_u32 vcc, s65, v83
    s_cbranch_vccnz L_kvf_r
    v_cmp_ne_u32 vcc, s65, v87
    s_cbranch_vccnz L_kvf_r
    v_cmp_ne_u32 vcc, s65, v183
    s_cbranch_vccnz L_kvf_r
L_kvf_ok:
    ds_write_b128 v194, v[80:83]
    ds_write_b128 v195, v[84:87] offset:1024
    v_cmp_ne_u32 vcc, s65, v186
    s_mov_b32 s55, 0
    v_mul_f32 v182, 0xbfb8aa3b, v182
    v_exp_f32 v182, v182
    s_waitcnt lgkmcnt(0)
    s_cbranch_vccnz L_noearly
    s_mov_b32 s55, 1
    s_mul_i32 s61, s52, 22528
    buffer_load_dwordx4 v[0:3], v222, s[40:43], s61 offen offset:0 sc1
    buffer_load_dwordx4 v[4:7], v223, s[40:43], s61 offen offset:0 sc1
    buffer_load_dwordx4 v[8:11], v222, s[40:43], s61 offen offset:1024 sc1
    buffer_load_dwordx4 v[12:15], v223, s[40:43], s61 offen offset:1024 sc1
    buffer_load_dwordx4 v[16:19], v222, s[40:43], s61 offen offset:2048 sc1
    buffer_load_dwordx4 v[20:23], v223, s[40:43], s61 offen offset:2048 sc1
    buffer_load_dwordx4 v[24:27], v222, s[40:43], s61 offen offset:3072 sc1
    buffer_load_dwordx4 v[28:31], v223, s[40:43], s61 offen offset:3072 sc1
    s_add_u32 s61, s61, 4096
    buffer_load_dwordx4 v[80:83], v222, s[40:43], s61 offen offset:0 sc1
    buffer_load_dwordx4 v[84:87], v223, s[40:43], s61 offen offset:0 sc1
    buffer_load_dwordx4 v[88:91], v222, s[40:43], s61 offen offset:1024 sc1
    buffer_load_dwordx4 v[92:95], v223, s[40:43], s61 offen offset:1024 sc1
L_noearly:
    s_barrier
    ds_read_b128 a[200:203], v247 offset:0
    ds_read_b128 a[204:207], v247 offset:640
    ds_read_b128 a[208:211], v247 offset:1280
    ds_read_b128 a[212:215], v247 offset:1920
    ds_read_b128 a[216:219], v247 offset:2560
    ds_read_b128 a[220:223], v247 offset:3200
    ds_read_b128 a[224:227], v247 offset:3840
    ds_read_b128 a[228:231], v247 offset:4480
    ds_read_b128 a[232:235], v247 offset:5120
    ds_read_b128 a[236:239], v247 offset:5760
    ds_read_b128 a[240:243], v247 offset:6400
    ds_read_b128 a[244:247], v247 offset:7040
    v_add_f32 v182, 1.0, v182
    v_min_f32 v182, 0x7149f2ca, v182
    v_mul_f32 v190, 0x358637bd, v182
    s_waitcnt lgkmcnt(9)
    v_mfma_f32_32x32x16_bf16 v[100:115], a[200:203], v[32:35], 0
    v_mfma_f32_32x32x16_bf16 v[100:115], a[204:207], v[36:39], v[100:115]
    v_mfma_f32_32x32x16_bf16 v[100:115], a[208:211], v[40:43], v[100:115]
    s_waitcnt lgkmcnt(6)
    v_mfma_f32_32x32x16_bf16 v[116:131], a[212:215], v[44:47], 0
    v_mfma_f32_32x32x16_bf16 v[116:131], a[216:219], v[48:51], v[116:131]
    v_mfma_f32_32x32x16_bf16 v[116:131], a[220:223], v[52:55], v[116:131]
    s_nop 5
    s_waitcnt lgkmcnt(3)
    v_mfma_f32_32x32x16_bf16 v[132:147], a[224:227], v[56:59], 0
    v_fma_f32 v108, v108, v182, v190
    v_rcp_f32 v108, v108
    s_nop 0
    v_mul_f32 v100, v108, v100
    v_mul_f32 v101, v108, v101
    v_mfma_f32_32x32x16_bf16 v[132:147], a[228:231], v[60:63], v[132:147]
    v_mul_f32 v102, v108, v102
    v_mul_f32 v103, v108, v103
    v_mul_f32 v104, v108, v104
    v_mul_f32 v105, v108, v105
    v_mul_f32 v106, v108, v106
    v_mul_f32_e64 v107, v108, v107
    v_mfma_f32_32x32x16_bf16 v[132:147], a[232:235], v[64:67], v[132:147]
    v_cvt_pk_bf16_f32 v112, v100, v101
    v_cvt_pk_bf16_f32 v113, v102, v103
    v_cvt_pk_bf16_f32 v114, v104, v105
    v_cvt_pk_bf16_f32 v115, v106, v107
    buffer_store_dwordx4 v[112:115], v180, s[40:43], s75 offen offset:0 sc1
    s_waitcnt lgkmcnt(0)
    v_mfma_f32_32x32x16_bf16 v[148:163], a[236:239], v[68:71], 0
    v_fma_f32 v124, v124, v182, v190
    v_rcp_f32 v124, v124
    s_nop 0
    v_mul_f32 v116, v124, v116
    v_mul_f32 v117, v124, v117
    v_mfma_f32_32x32x16_bf16 v[148:163], a[240:243], v[72:75], v[148:163]
    v_mul_f32 v118, v124, v118
    v_mul_f32 v119, v124, v119
    v_mul_f32 v120, v124, v120
    v_mul_f32 v121, v124, v121
    v_mul_f32 v122, v124, v122
    v_mul_f32_e64 v123, v124, v123
    v_mfma_f32_32x32x16_bf16 v[148:163], a[244:247], v[76:79], v[148:163]
    v_cvt_pk_bf16_f32 v128, v116, v117
    v_cvt_pk_bf16_f32 v129, v118, v119
    v_cvt_pk_bf16_f32 v130, v120, v121
    v_cvt_pk_bf16_f32 v131, v122, v123
    buffer_store_dwordx4 v[128:131], v180, s[40:43], s75 offen offset:1024 sc1
    v_fma_f32 v140, v140, v182, v190
    v_rcp_f32 v140, v140
    s_nop 0
    v_mul_f32 v132, v140, v132
    v_mul_f32 v133, v140, v133
    v_mul_f32 v134, v140, v134
    v_mul_f32 v135, v140, v135
    v_mul_f32 v136, v140, v136
    v_mul_f32 v137, v140, v137
    v_mul_f32 v138, v140, v138
    v_mul_f32 v139, v140, v139
    v_cvt_pk_bf16_f32 v144, v132, v133
    v_cvt_pk_bf16_f32 v145, v134, v135
    v_cvt_pk_bf16_f32 v146, v136, v137
    v_cvt_pk_bf16_f32 v147, v138, v139
    buffer_store_dwordx4 v[144:147], v180, s[40:43], s75 offen offset:2048 sc1
    v_fma_f32 v156, v156, v182, v190
    v_rcp_f32 v156, v156
    s_nop 0
    v_mul_f32 v148, v156, v148
    v_mul_f32 v149, v156, v149
    v_mul_f32 v150, v156, v150
    v_mul_f32 v151, v156, v151
    v_mul_f32 v152, v156, v152
    v_mul_f32 v153, v156, v153
    v_mul_f32 v154, v156, v154
    v_mul_f32 v155, v156, v155
    v_cvt_pk_bf16_f32 v160, v148, v149
    v_cvt_pk_bf16_f32 v161, v150, v151
    v_cvt_pk_bf16_f32 v162, v152, v153
    v_cvt_pk_bf16_f32 v163, v154, v155
    buffer_store_dwordx4 v[160:163], v180, s[40:43], s75 offen offset:3072 sc1
    s_cmp_eq_u32 s55, 0
    s_cbranch_scc1 L_late
L_late_ok:
L_s0:
    s_add_u32 s64, s74, 135168
    s_mov_b32 s44, s24
    s_mov_b32 s45, s25
    s_mov_b32 s46, 2097152
    s_mov_b32 s47, 0x20000
    s_waitcnt vmcnt(10)
    v_mfma_f32_32x32x16_bf16 v[100:115], a[0:3], v[0:3], 0
    s_mul_i32 s61, s52, 22528
    s_add_u32 s61, s61, 16384
    buffer_load_dwordx4 v[200:203], v222, s[40:43], s61 offen offset:0 sc1
    v_mfma_f32_32x32x16_bf16 v[116:131], a[4:7], v[0:3], 0
    ds_read_b64_tr_b16 a[120:121], v216 offset:0
    ds_read_b64_tr_b16 a[122:123], v216 offset:1024
    ds_read_b64_tr_b16 a[124:125], v217 offset:0
    ds_read_b64_tr_b16 a[126:127], v217 offset:1024
    v_mfma_f32_32x32x16_bf16 v[132:147], a[0:3], v[4:7], 0
    buffer_load_dwordx4 v[204:207], v223, s[40:43], s61 offen offset:0 sc1
    v_mfma_f32_32x32x16_bf16 v[148:163], a[4:7], v[4:7], 0
    ds_read_b64_tr_b16 a[128:129], v216 offset:2048
    ds_read_b64_tr_b16 a[130:131], v216 offset:3072
    ds_read_b64_tr_b16 a[132:133], v217 offset:2048
    ds_read_b64_tr_b16 a[134:135], v217 offset:3072
    buffer_load_dword v186, v225, s[40:43], s64 offen sc1
    s_waitcnt vmcnt(11)
    v_mfma_f32_32x32x16_bf16 v[100:115], a[8:11], v[8:11], v[100:115]
    buffer_load_dwordx4 v[208:211], v222, s[40:43], s61 offen offset:1024 sc1
    v_mfma_f32_32x32x16_bf16 v[116:131], a[12:15], v[8:11], v[116:131]
    ds_read_b64_tr_b16 a[136:137], v216 offset:4096
    ds_read_b64_tr_b16 a[138:139], v216 offset:5120
    ds_read_b64_tr_b16 a[140:141], v217 offset:4096
    ds_read_b64_tr_b16 a[142:143], v217 offset:5120
    v_mfma_f32_32x32x16_bf16 v[132:147], a[8:11], v[12:15], v[132:147]
    buffer_load_dwordx4 v[212:215], v223, s[40:43], s61 offen offset:1024 sc1
    v_mfma_f32_32x32x16_bf16 v[148:163], a[12:15], v[12:15], v[148:163]
    ds_read_b64_tr_b16 a[144:145], v216 offset:6144
    ds_read_b64_tr_b16 a[146:147], v216 offset:7168
    ds_read_b64_tr_b16 a[148:149], v217 offset:6144
    ds_read_b64_tr_b16 a[150:151], v217 offset:7168
    s_waitcnt vmcnt(11)
    v_mfma_f32_32x32x16_bf16 v[100:115], a[16:19], v[16:19], v[100:115]
    buffer_load_dwordx4 v[0:3], v222, s[40:43], s61 offen offset:2048 sc1
    v_mfma_f32_32x32x16_bf16 v[116:131], a[20:23], v[16:19], v[116:131]
    ds_read_b64_tr_b16 a[152:153], v216 offset:8192
    ds_read_b64_tr_b16 a[154:155], v216 offset:9216
    ds_read_b64_tr_b16 a[156:157], v217 offset:8192
    ds_read_b64_tr_b16 a[158:159], v217 offset:9216
    v_mfma_f32_32x32x16_bf16 v[132:147], a[16:19], v[20:23], v[132:147]
    buffer_load_dwordx4 v[4:7], v223, s[40:43], s61 offen offset:2048 sc1
    v_mfma_f32_32x32x16_bf16 v[148:163], a[20:23], v[20:23], v[148:163]
    ds_read_b64_tr_b16 a[160:161], v218 offset:0
    ds_read_b64_tr_b16 a[162:163], v218 offset:1024
    ds_read_b64_tr_b16 a[164:165], v219 offset:0
    ds_read_b64_tr_b16 a[166:167], v219 offset:1024
    s_waitcnt vmcnt(11)
    v_mfma_f32_32x32x16_bf16 v[100:115], a[24:27], v[24:27], v[100:115]
    buffer_load_dwordx4 v[8:11], v222, s[40:43], s61 offen offset:3072 sc1
    v_mfma_f32_32x32x16_bf16 v[116:131], a[28:31], v[24:27], v[116:131]
    ds_read_b64_tr_b16 a[168:169], v218 offset:2048
    ds_read_b64_tr_b16 a[170:171], v218 offset:3072
    ds_read_b64_tr_b16 a[172:173], v219 offset:2048
    ds_read_b64_tr_b16 a[174:175], v219 offset:3072
    v_mfma_f32_32x32x16_bf16 v[132:147], a[24:27], v[28:31], v[132:147]
    buffer_load_dwordx4 v[12:15], v223, s[40:43], s61 offen offset:3072 sc1
    v_mfma_f32_32x32x16_bf16 v[148:163], a[28:31], v[28:31], v[148:163]
    ds_read_b64_tr_b16 a[176:177], v218 offset:4096
    ds_read_b64_tr_b16 a[178:179], v218 offset:5120
    ds_read_b64_tr_b16 a[180:181], v219 offset:4096
    ds_read_b64_tr_b16 a[182:183], v219 offset:5120
    s_waitcnt vmcnt(11)
    v_mfma_f32_32x32x16_bf16 v[100:115], a[32:35], v[80:83], v[100:115]
    s_add_u32 s61, s61, 4096
    buffer_load_dwordx4 v[16:19], v222, s[40:43], s61 offen offset:0 sc1
    v_mfma_f32_32x32x16_bf16 v[116:131], a[36:39], v[80:83], v[116:131]
    ds_read_b64_tr_b16 a[184:185], v218 offset:6144
    ds_read_b64_tr_b16 a[186:187], v218 offset:7168
    ds_read_b64_tr_b16 a[188:189], v219 offset:6144
    ds_read_b64_tr_b16 a[190:191], v219 offset:7168
    v_mfma_f32_32x32x16_bf16 v[132:147], a[32:35], v[84:87], v[132:147]
    buffer_load_dwordx4 v[20:23], v223, s[40:43], s61 offen offset:0 sc1
    v_mfma_f32_32x32x16_bf16 v[148:163], a[36:39], v[84:87], v[148:163]
    ds_read_b64_tr_b16 a[192:193], v218 offset:8192
    ds_read_b64_tr_b16 a[194:195], v218 offset:9216
    ds_read_b64_tr_b16 a[196:197], v219 offset:8192
    ds_read_b64_tr_b16 a[198:199], v219 offset:9216
    s_waitcnt vmcnt(11)
    v_mfma_f32_32x32x16_bf16 v[100:115], a[40:43], v[88:91], v[100:115]
    buffer_load_dwordx4 v[24:27], v222, s[40:43], s61 offen offset:1024 sc1
    v_mfma_f32_32x32x16_bf16 v[116:131], a[44:47], v[88:91], v[116:131]
    ds_read_b64_tr_b16 a[80:81], v220 offset:0
    ds_read_b64_tr_b16 a[82:83], v220 offset:1024
    ds_read_b64_tr_b16 a[84:85], v221 offset:0
    ds_read_b64_tr_b16 a[86:87], v221 offset:1024
    v_mfma_f32_32x32x16_bf16 v[132:147], a[40:43], v[92:95], v[132:147]
    buffer_load_dwordx4 v[28:31], v223, s[40:43], s61 offen offset:1024 sc1
    v_mfma_f32_32x32x16_bf16 v[148:163], a[44:47], v[92:95], v[148:163]
    ds_read_b64_tr_b16 a[88:89], v220 offset:2048
    ds_read_b64_tr_b16 a[90:91], v220 offset:3072
    ds_read_b64_tr_b16 a[92:93], v221 offset:2048
    ds_read_b64_tr_b16 a[94:95], v221 offset:3072
    s_waitcnt lgkmcnt(15)
    s_waitcnt vmcnt(11)
    v_mfma_f32_32x32x16_bf16 v[100:115], a[128:131], v[200:203], v[100:115]
    buffer_store_dword v184, v226, s[40:43], s73 offen sc1
    s_waitcnt vmcnt(11)
    v_cmp_ne_u32 vcc, s65, v186
    s_cbranch_vccnz L_h2_r
L_h2_ok:
    s_mul_i32 s61, s52, 22528
    s_add_u32 s61, s61, 6144
    buffer_load_dwordx4 v[80:83], v222, s[40:43], s61 offen offset:0 sc1
    v_mfma_f32_32x32x16_bf16 v[116:131], a[132:135], v[200:203], v[116:131]
    ds_read_b64_tr_b16 a[96:97], v220 offset:4096
    ds_read_b64_tr_b16 a[98:99], v220 offset:5120
    ds_read_b64_tr_b16 a[100:101], v221 offset:4096
    ds_read_b64_tr_b16 a[102:103], v221 offset:5120
    v_mfma_f32_32x32x16_bf16 v[132:147], a[128:131], v[204:207], v[132:147]
    buffer_load_dwordx4 v[84:87], v223, s[40:43], s61 offen offset:0 sc1
    v_mfma_f32_32x32x16_bf16 v[148:163], a[132:135], v[204:207], v[148:163]
    ds_read_b64_tr_b16 a[104:105], v220 offset:6144
    ds_read_b64_tr_b16 a[106:107], v220 offset:7168
    ds_read_b64_tr_b16 a[108:109], v221 offset:6144
    ds_read_b64_tr_b16 a[110:111], v221 offset:7168
    s_waitcnt vmcnt(11)
    v_mfma_f32_32x32x16_bf16 v[100:115], a[136:139], v[208:211], v[100:115]
    buffer_load_dwordx4 v[88:91], v222, s[40:43], s61 offen offset:1024 sc1
    v_mfma_f32_32x32x16_bf16 v[116:131], a[140:143], v[208:211], v[116:131]
    ds_read_b64_tr_b16 a[112:113], v220 offset:8192
    ds_read_b64_tr_b16 a[114:115], v220 offset:9216
    ds_read_b64_tr_b16 a[116:117], v221 offset:8192
    ds_read_b64_tr_b16 a[118:119], v221 offset:9216
    v_mfma_f32_32x32x16_bf16 v[132:147], a[136:139], v[212:215], v[132:147]
    buffer_load_dwordx4 v[92:95], v223, s[40:43], s61 offen offset:1024 sc1
    v_mfma_f32_32x32x16_bf16 v[148:163], a[140:143], v[212:215], v[148:163]
    s_waitcnt vmcnt(11)
    v_mfma_f32_32x32x16_bf16 v[100:115], a[144:147], v[0:3], v[100:115]
    buffer_load_dwordx4 v[200:203], v222, s[40:43], s61 offen offset:2048 sc1
    v_mfma_f32_32x32x16_bf16 v[116:131], a[148:151], v[0:3], v[116:131]
    s_waitcnt lgkmcnt(0)
    s_cmp_lg_u32 s52, 3
    s_cbranch_scc1 L_nob2
    v_lshl_or_b32 v234, v234, 16, v234
    v_lshl_or_b32 v235, v235, 16, v235
    v_accvgpr_write_b32 a80, v234
    v_accvgpr_write_b32 a84, v235
L_nob2:
    v_mfma_f32_32x32x16_bf16 v[132:147], a[144:147], v[4:7], v[132:147]
    buffer_load_dwordx4 v[204:207], v223, s[40:43], s61 offen offset:2048 sc1
    v_mfma_f32_32x32x16_bf16 v[148:163], a[148:151], v[4:7], v[148:163]
    s_lshl_b32 s49, s52, 17
    s_add_u32 s49, s49, 81920
    s_mov_b32 s48, s49
    s_mov_b32 m0, s66
    s_waitcnt vmcnt(11)
    v_mfma_f32_32x32x16_bf16 v[100:115], a[152:155], v[8:11], v[100:115]
    buffer_load_dwordx4 v[208:211], v222, s[40:43], s61 offen offset:3072 sc1
    v_mfma_f32_32x32x16_bf16 v[116:131], a[156:159], v[8:11], v[116:131]
    buffer_load_dwordx4 v164, s[36:39], s48 offen offset:0 lds
    v_mfma_f32_32x32x16_bf16 v[132:147], a[152:155], v[12:15], v[132:147]
    buffer_load_dwordx4 v[212:215], v223, s[40:43], s61 offen offset:3072 sc1
    v_mfma_f32_32x32x16_bf16 v[148:163], a[156:159], v[12:15], v[148:163]
    buffer_load_dwordx4 v165, s[36:39], s48 offen offset:1024 lds
    s_waitcnt vmcnt(13)
    v_mfma_f32_32x32x16_bf16 v[100:115], a[160:163], v[16:19], v[100:115]
    s_add_u32 s61, s61, 4096
    buffer_load_dwordx4 v[0:3], v222, s[40:43], s61 offen offset:0 sc1
    v_mfma_f32_32x32x16_bf16 v[116:131], a[164:167], v[16:19], v[116:131]
    buffer_load_dwordx4 v166, s[36:39], s48 offen offset:2048 lds
    v_mfma_f32_32x32x16_bf16 v[132:147], a[160:163], v[20:23], v[132:147]
    buffer_load_dwordx4 v[4:7], v223, s[40:43], s61 offen offset:0 sc1
    v_mfma_f32_32x32x16_bf16 v[148:163], a[164:167], v[20:23], v[148:163]
    buffer_load_dwordx4 v167, s[36:39], s48 offen offset:3072 lds
    buffer_load_dword v186, v225, s[40:43], s74 offen sc1
    s_waitcnt vmcnt(16)
    v_mfma_f32_32x32x16_bf16 v[100:115], a[168:171], v[24:27], v[100:115]
    buffer_load_dwordx4 v[8:11], v222, s[40:43], s61 offen offset:1024 sc1
    v_mfma_f32_32x32x16_bf16 v[116:131], a[172:175], v[24:27], v[116:131]
    s_add_u32 m0, m0, 4096
    v_mfma_f32_32x32x16_bf16 v[132:147], a[168:171], v[28:31], v[132:147]
    buffer_load_dwordx4 v[12:15], v223, s[40:43], s61 offen offset:1024 sc1
    v_mfma_f32_32x32x16_bf16 v[148:163], a[172:175], v[28:31], v[148:163]
    buffer_load_dwordx4 v168, s[36:39], s49 offen offset:0 lds
    s_waitcnt vmcnt(16)
    v_mfma_f32_32x32x16_bf16 v[100:115], a[48:51], v[80:83], v[100:115]
    buffer_load_dwordx4 v[16:19], v222, s[40:43], s61 offen offset:2048 sc1
    v_mfma_f32_32x32x16_bf16 v[116:131], a[52:55], v[80:83], v[116:131]
    buffer_load_dwordx4 v169, s[36:39], s49 offen offset:1024 lds
    v_mfma_f32_32x32x16_bf16 v[132:147], a[48:51], v[84:87], v[132:147]
    buffer_load_dwordx4 v[20:23], v223, s[40:43], s61 offen offset:2048 sc1
    v_mfma_f32_32x32x16_bf16 v[148:163], a[52:55], v[84:87], v[148:163]
    buffer_load_dwordx4 v170, s[36:39], s49 offen offset:2048 lds
    s_waitcnt vmcnt(18)
    v_mfma_f32_32x32x16_bf16 v[100:115], a[56:59], v[88:91], v[100:115]
    buffer_load_dwordx4 v[24:27], v222, s[40:43], s61 offen offset:3072 sc1
    v_mfma_f32_32x32x16_bf16 v[116:131], a[60:63], v[88:91], v[116:131]
    buffer_load_dwordx4 v171, s[36:39], s49 offen offset:3072 lds
    v_mfma_f32_32x32x16_bf16 v[132:147], a[56:59], v[92:95], v[132:147]
    buffer_load_dwordx4 v[28:31], v223, s[40:43], s61 offen offset:3072 sc1
    v_mfma_f32_32x32x16_bf16 v[148:163], a[60:63], v[92:95], v[148:163]
    s_add_u32 m0, m0, 4096
    s_waitcnt vmcnt(19)
    v_mfma_f32_32x32x16_bf16 v[100:115], a[64:67], v[200:203], v[100:115]
    s_add_u32 s61, s61, 4096
    buffer_load_dwordx4 v[80:83], v222, s[40:43], s61 offen offset:0 sc1
    v_mfma_f32_32x32x16_bf16 v[116:131], a[68:71], v[200:203], v[116:131]
    buffer_load_dwordx4 v172, s[36:39], s49 offen offset:0 lds
    v_mfma_f32_32x32x16_bf16 v[132:147], a[64:67], v[204:207], v[132:147]
    buffer_load_dwordx4 v[84:87], v223, s[40:43], s61 offen offset:0 sc1
    v_mfma_f32_32x32x16_bf16 v[148:163], a[68:71], v[204:207], v[148:163]
    buffer_load_dwordx4 v173, s[36:39], s49 offen offset:1024 lds
    s_waitcnt vmcnt(20)
    v_mfma_f32_32x32x16_bf16 v[100:115], a[72:75], v[208:211], v[100:115]
    buffer_load_dwordx4 v[88:91], v222, s[40:43], s61 offen offset:1024 sc1
    v_mfma_f32_32x32x16_bf16 v[116:131], a[76:79], v[208:211], v[116:131]
    v_mfma_f32_32x32x16_bf16 v[132:147], a[72:75], v[212:215], v[132:147]
    buffer_load_dwordx4 v[92:95], v223, s[40:43], s61 offen offset:1024 sc1
    v_mfma_f32_32x32x16_bf16 v[148:163], a[76:79], v[212:215], v[148:163]
    s_waitcnt vmcnt(18)
    v_mfma_f32_32x32x16_bf16 v[100:115], a[80:83], v[0:3], v[100:115]
    s_waitcnt vmcnt(16)
    v_cmp_ne_u32 vcc, s65, v186
    s_cbranch_vccnz L_op_r
L_op_ok:
    s_lshl_b32 s61, s52, 13
    s_add_u32 s61, s61, 90112
    buffer_load_dwordx4 v[200:203], v222, s[40:43], s61 offen offset:0 sc1
    v_mfma_f32_32x32x16_bf16 v[116:131], a[84:87], v[0:3], v[116:131]
    v_mfma_f32_32x32x16_bf16 v[132:147], a[80:83], v[4:7], v[132:147]
    buffer_load_dwordx4 v[204:207], v223, s[40:43], s61 offen offset:0 sc1
    v_mfma_f32_32x32x16_bf16 v[148:163], a[84:87], v[4:7], v[148:163]
    s_waitcnt vmcnt(16)
    v_mfma_f32_32x32x16_bf16 v[100:115], a[88:91], v[8:11], v[100:115]
    buffer_load_dwordx4 v[208:211], v222, s[40:43], s61 offen offset:1024 sc1
    v_mfma_f32_32x32x16_bf16 v[116:131], a[92:95], v[8:11], v[116:131]
    v_mfma_f32_32x32x16_bf16 v[132:147], a[88:91], v[12:15], v[132:147]
    buffer_load_dwordx4 v[212:215], v223, s[40:43], s61 offen offset:1024 sc1
    v_mfma_f32_32x32x16_bf16 v[148:163], a[92:95], v[12:15], v[148:163]
    s_waitcnt vmcnt(14)
    v_mfma_f32_32x32x16_bf16 v[100:115], a[96:99], v[16:19], v[100:115]
    buffer_load_dwordx4 v[0:3], v222, s[40:43], s61 offen offset:2048 sc1
    v_mfma_f32_32x32x16_bf16 v[116:131], a[100:103], v[16:19], v[116:131]
    v_mfma_f32_32x32x16_bf16 v[132:147], a[96:99], v[20:23], v[132:147]
    buffer_load_dwordx4 v[4:7], v223, s[40:43], s61 offen offset:2048 sc1
    v_mfma_f32_32x32x16_bf16 v[148:163], a[100:103], v[20:23], v[148:163]
    s_waitcnt vmcnt(12)
    v_mfma_f32_32x32x16_bf16 v[100:115], a[104:107], v[24:27], v[100:115]
    buffer_load_dwordx4 v[8:11], v222, s[40:43], s61 offen offset:3072 sc1
    v_mfma_f32_32x32x16_bf16 v[116:131], a[108:111], v[24:27], v[116:131]
    v_mfma_f32_32x32x16_bf16 v[132:147], a[104:107], v[28:31], v[132:147]
    buffer_load_dwordx4 v[12:15], v223, s[40:43], s61 offen offset:3072 sc1
    v_mfma_f32_32x32x16_bf16 v[148:163], a[108:111], v[28:31], v[148:163]
    s_waitcnt vmcnt(11)
    v_mfma_f32_32x32x16_bf16 v[100:115], a[112:115], v[80:83], v[100:115]
    s_add_u32 s61, s61, 4096
    buffer_load_dwordx4 v[16:19], v222, s[40:43], s61 offen offset:0 sc1
    v_mfma_f32_32x32x16_bf16 v[116:131], a[116:119], v[80:83], v[116:131]
    v_mfma_f32_32x32x16_bf16 v[132:147], a[112:115], v[84:87], v[132:147]
    buffer_load_dwordx4 v[20:23], v223, s[40:43], s61 offen offset:0 sc1
    v_mfma_f32_32x32x16_bf16 v[148:163], a[116:119], v[84:87], v[148:163]
    s_waitcnt vmcnt(10)
    v_mfma_f32_32x32x16_bf16 v[100:115], a[120:123], v[88:91], v[100:115]
    buffer_load_dwordx4 v[24:27], v222, s[40:43], s61 offen offset:1024 sc1
    v_mfma_f32_32x32x16_bf16 v[116:131], a[124:127], v[88:91], v[116:131]
    ds_read_b64_tr_b16 a[200:201], v216 offset:0
    ds_read_b64_tr_b16 a[202:203], v216 offset:1024
    ds_read_b64_tr_b16 a[204:205], v217 offset:0
    v_mfma_f32_32x32x16_bf16 v[132:147], a[120:123], v[92:95], v[132:147]
    buffer_load_dwordx4 v[28:31], v223, s[40:43], s61 offen offset:1024 sc1
    v_mfma_f32_32x32x16_bf16 v[148:163], a[124:127], v[92:95], v[148:163]
    ds_read_b64_tr_b16 a[206:207], v217 offset:1024
    ds_read_b64_tr_b16 a[208:209], v216 offset:2048
    ds_read_b64_tr_b16 a[210:211], v216 offset:3072
    s_waitcnt vmcnt(10)
    v_mfma_f32_32x32x16_bf16 v[100:115], a[176:179], v[200:203], v[100:115]
    buffer_load_dwordx4 v[80:83], v222, s[40:43], s61 offen offset:2048 sc1
    v_mfma_f32_32x32x16_bf16 v[116:131], a[180:183], v[200:203], v[116:131]
    ds_read_b64_tr_b16 a[212:213], v217 offset:2048
    ds_read_b64_tr_b16 a[214:215], v217 offset:3072
    ds_read_b64_tr_b16 a[216:217], v216 offset:4096
    ds_read_b64_tr_b16 a[218:219], v216 offset:5120
    v_mfma_f32_32x32x16_bf16 v[132:147], a[176:179], v[204:207], v[132:147]
    buffer_load_dwordx4 v[84:87], v223, s[40:43], s61 offen offset:2048 sc1
    v_mfma_f32_32x32x16_bf16 v[148:163], a[180:183], v[204:207], v[148:163]
    ds_read_b64_tr_b16 a[220:221], v217 offset:4096
    ds_read_b64_tr_b16 a[222:223], v217 offset:5120
    ds_read_b64_tr_b16 a[224:225], v216 offset:6144
    s_waitcnt vmcnt(10)
    v_mfma_f32_32x32x16_bf16 v[100:115], a[184:187], v[208:211], v[100:115]
    buffer_load_dwordx4 v[88:91], v222, s[40:43], s61 offen offset:3072 sc1
    v_mfma_f32_32x32x16_bf16 v[116:131], a[188:191], v[208:211], v[116:131]
    ds_read_b64_tr_b16 a[226:227], v216 offset:7168
    ds_read_b64_tr_b16 a[228:229], v217 offset:6144
    ds_read_b64_tr_b16 a[230:231], v217 offset:7168
    ds_read_b64_tr_b16 a[232:233], v216 offset:8192
    v_mfma_f32_32x32x16_bf16 v[132:147], a[184:187], v[212:215], v[132:147]
    buffer_load_dwordx4 v[92:95], v223, s[40:43], s61 offen offset:3072 sc1
    v_mfma_f32_32x32x16_bf16 v[148:163], a[188:191], v[212:215], v[148:163]
    ds_read_b64_tr_b16 a[234:235], v216 offset:9216
    ds_read_b64_tr_b16 a[236:237], v217 offset:8192
    ds_read_b64_tr_b16 a[238:239], v217 offset:9216
    s_waitcnt vmcnt(10)
    v_mfma_f32_32x32x16_bf16 v[100:115], a[192:195], v[0:3], v[100:115]
    v_mfma_f32_32x32x16_bf16 v[116:131], a[196:199], v[0:3], v[116:131]
    v_mfma_f32_32x32x16_bf16 v[132:147], a[192:195], v[4:7], v[132:147]
    v_mfma_f32_32x32x16_bf16 v[148:163], a[196:199], v[4:7], v[148:163]
    s_waitcnt lgkmcnt(0)
    s_waitcnt vmcnt(8)
    v_mfma_f32_32x32x16_bf16 v[100:115], a[200:203], v[8:11], v[100:115]
    v_mfma_f32_32x32x16_bf16 v[116:131], a[204:207], v[8:11], v[116:131]
    v_mfma_f32_32x32x16_bf16 v[132:147], a[200:203], v[12:15], v[132:147]
    v_mfma_f32_32x32x16_bf16 v[148:163], a[204:207], v[12:15], v[148:163]
    s_waitcnt vmcnt(6)
    v_mfma_f32_32x32x16_bf16 v[100:115], a[208:211], v[16:19], v[100:115]
    v_mfma_f32_32x32x16_bf16 v[116:131], a[212:215], v[16:19], v[116:131]
    v_mfma_f32_32x32x16_bf16 v[132:147], a[208:211], v[20:23], v[132:147]
    v_mfma_f32_32x32x16_bf16 v[148:163], a[212:215], v[20:23], v[148:163]
    s_waitcnt vmcnt(4)
    v_mfma_f32_32x32x16_bf16 v[116:131], a[220:223], v[24:27], v[116:131]
    v_mfma_f32_32x32x16_bf16 v[132:147], a[216:219], v[28:31], v[132:147]
    s_waitcnt vmcnt(2)
    v_mfma_f32_32x32x16_bf16 v[116:131], a[228:231], v[80:83], v[116:131]
    s_waitcnt vmcnt(0)
    v_mfma_f32_32x32x16_bf16 v[116:131], a[236:239], v[88:91], v[116:131]
    v_mfma_f32_32x32x16_bf16 v[132:147], a[224:227], v[84:87], v[132:147]
    v_mfma_f32_32x32x16_bf16 v[132:147], a[232:235], v[92:95], v[132:147]
    v_mfma_f32_32x32x16_bf16 v[148:163], a[220:223], v[28:31], v[148:163]
    s_nop 7
    s_nop 0
    ds_write_b128 v227, v[116:119] offset:0
    ds_write_b128 v227, v[120:123] offset:1024
    v_mfma_f32_32x32x16_bf16 v[148:163], a[228:231], v[84:87], v[148:163]
    ds_write_b128 v227, v[124:127] offset:2048
    ds_write_b128 v227, v[128:131] offset:3072
    v_mfma_f32_32x32x16_bf16 v[148:163], a[236:239], v[92:95], v[148:163]
    ds_write_b128 v227, v[132:135] offset:4096
    v_mfma_f32_32x32x16_bf16 v[100:115], a[216:219], v[24:27], v[100:115]
    ds_write_b128 v227, v[136:139] offset:5120
    ds_write_b128 v227, v[140:143] offset:6144
    v_mfma_f32_32x32x16_bf16 v[100:115], a[224:227], v[80:83], v[100:115]
    ds_write_b128 v227, v[144:147] offset:7168
    v_mfma_f32_32x32x16_bf16 v[100:115], a[232:235], v[88:91], v[100:115]
    s_nop 3
    s_nop 0
    ds_write_b128 v228, v[148:151] offset:0
    ds_write_b128 v228, v[152:155] offset:1024
    ds_write_b128 v228, v[156:159] offset:2048
    ds_write_b128 v228, v[160:163] offset:3072
    s_waitcnt lgkmcnt(0)
    s_barrier
    ds_read_b128 v[116:119], v229 offset:0
    ds_read_b128 v[120:123], v229 offset:1024
    ds_read_b128 v[124:127], v229 offset:2048
    ds_read_b128 v[128:131], v229 offset:3072
    ds_read_b128 v[132:135], v230 offset:0
    ds_read_b128 v[136:139], v230 offset:1024
    ds_read_b128 v[140:143], v230 offset:2048
    ds_read_b128 v[144:147], v230 offset:3072
    ds_read_b128 v[148:151], v231 offset:0
    ds_read_b128 v[152:155], v231 offset:1024
    ds_read_b128 v[156:159], v231 offset:2048
    ds_read_b128 v[160:163], v231 offset:3072
    s_waitcnt lgkmcnt(8)
    v_pk_add_f32 v[100:101], v[100:101], v[116:117]
    v_pk_add_f32 v[102:103], v[102:103], v[118:119]
    v_pk_add_f32 v[104:105], v[104:105], v[120:121]
    v_pk_add_f32 v[106:107], v[106:107], v[122:123]
    v_pk_add_f32 v[108:109], v[108:109], v[124:125]
    v_pk_add_f32 v[110:111], v[110:111], v[126:127]
    v_pk_add_f32 v[112:113], v[112:113], v[128:129]
    v_pk_add_f32 v[114:115], v[114:115], v[130:131]
    s_waitcnt lgkmcnt(4)
    s_nop 0
    v_pk_add_f32 v[100:101], v[100:101], v[132:133]
    v_pk_add_f32 v[102:103], v[102:103], v[134:135]
    v_pk_add_f32 v[104:105], v[104:105], v[136:137]
    v_pk_add_f32 v[106:107], v[106:107], v[138:139]
    v_pk_add_f32 v[108:109], v[108:109], v[140:141]
    v_pk_add_f32 v[110:111], v[110:111], v[142:143]
    v_pk_add_f32 v[112:113], v[112:113], v[144:145]
    v_pk_add_f32 v[114:115], v[114:115], v[146:147]
    s_waitcnt lgkmcnt(0)
    s_nop 0
    v_pk_add_f32 v[100:101], v[100:101], v[148:149]
    v_pk_add_f32 v[102:103], v[102:103], v[150:151]
    v_pk_add_f32 v[104:105], v[104:105], v[152:153]
    v_pk_add_f32 v[106:107], v[106:107], v[154:155]
    v_pk_add_f32 v[108:109], v[108:109], v[156:157]
    v_pk_add_f32 v[110:111], v[110:111], v[158:159]
    v_pk_add_f32 v[112:113], v[112:113], v[160:161]
    v_pk_add_f32 v[114:115], v[114:115], v[162:163]
    v_cvt_pk_bf16_f32 v16, v100, v101
    v_cvt_pk_bf16_f32 v17, v102, v103
    v_cvt_pk_bf16_f32 v18, v104, v105
    v_cvt_pk_bf16_f32 v19, v106, v107
    v_cvt_pk_bf16_f32 v20, v108, v109
    v_cvt_pk_bf16_f32 v21, v110, v111
    v_cvt_pk_bf16_f32 v22, v112, v113
    v_cvt_pk_bf16_f32 v23, v114, v115
    v_permlane32_swap_b32 v16, v18
    v_permlane32_swap_b32 v17, v19
    buffer_store_dwordx4 v[16:19], v224, s[44:47], 0 offen
    v_permlane32_swap_b32 v20, v22
    v_permlane32_swap_b32 v21, v23
    buffer_store_dwordx4 v[20:23], v224, s[44:47], 0 offen offset:32
L_exit:
    s_endpgm
L_nonce:
    s_add_u32 s3, s3, 1
    s_and_b32 s67, s3, 0xbfffbfff
    s_or_b32 s67, s67, 0x2000
    v_mov_b32 v194, s67
    v_mov_b32 v195, s3
    s_mov_b64 exec, 1
    global_store_dword v181, v194, s[26:27] sc1
    global_store_dword v181, v195, s[12:13] sc1
    s_mov_b64 exec, -1
    s_branch L_nonce_ok
L_tag3_r:
    s_mov_b32 s67, 0
L_tag3:
    global_load_dword v184, v181, s[26:27] sc1
    s_add_u32 s67, s67, 1
    s_waitcnt vmcnt(0)
    v_readfirstlane_b32 s65, v184
    s_cmp_ge_u32 s67, 1048576
    s_cbranch_scc1 L_tag3_ok
    s_cmp_eq_u32 s65, 0
    s_cbranch_scc1 L_tag3
    s_branch L_tag3_ok
L_biasblk:
    v_rcp_f32 v100, v182
    v_mov_b32 v125, 0
    v_mov_b32 v126, 0
    v_mov_b32 v127, 0
    v_mov_b32 v128, 0
    v_mov_b32 v129, 0
    v_mov_b32 v130, 0
    v_mov_b32 v131, 0
    v_cvt_pk_bf16_f32 v101, v100, v100
    v_lshlrev_b32 v101, 16, v101
    v_sub_f32 v101, v100, v101
    v_cvt_pk_bf16_f32 v124, v100, v101
    v_cmp_gt_u32 vcc, 32, v179
    s_nop 1
    v_cndmask_b32 v124, 0, v124, vcc
    s_branch L_blk5st
L_h1f_r:
    s_mov_b32 s67, 0
L_h1f:
    buffer_load_dword v186, v225, s[40:43], s64 offen sc1
    s_add_u32 s67, s67, 1
    s_cmp_ge_u32 s67, 1048576
    s_waitcnt vmcnt(0)
    s_cbranch_scc1 L_h1f_x
    v_cmp_ne_u32 vcc, s65, v186
    s_cbranch_vccnz L_h1f
L_h1f_x:
    s_branch L_h1f_ok
L_tag5_r:
    s_mov_b32 s67, 0
L_tag5:
    global_load_dword v184, v181, s[26:27] sc1
    s_add_u32 s67, s67, 1
    s_waitcnt vmcnt(0)
    v_readfirstlane_b32 s65, v184
    s_cmp_ge_u32 s67, 1048576
    s_cbranch_scc1 L_tag5_ok
    s_cmp_eq_u32 s65, 0
    s_cbranch_scc1 L_tag5
    s_branch L_tag5_ok
L_red_r:
    s_mov_b32 s67, 0
L_red:
    buffer_load_dwordx4 v[132:135], v252, s[40:43], s0 offen sc1
    buffer_load_dwordx4 v[136:139], v252, s[40:43], s76 offen sc1
    buffer_load_dwordx4 v[140:143], v252, s[40:43], s3 offen sc1
    buffer_load_dwordx4 v[144:147], v252, s[40:43], s50 offen sc1
    s_add_u32 s67, s67, 1
    s_cmp_ge_u32 s67, 1048576
    s_waitcnt vmcnt(0)
    s_cbranch_scc1 L_red_x
    v_cmp_ne_u32 vcc, s65, v135
    s_cbranch_vccnz L_red
    v_cmp_ne_u32 vcc, s65, v139
    s_cbranch_vccnz L_red
    v_cmp_ne_u32 vcc, s65, v143
    s_cbranch_vccnz L_red
    v_cmp_ne_u32 vcc, s65, v147
    s_cbranch_vccnz L_red
L_red_x:
    s_branch L_red_ok
L_kvf_r:
    s_mov_b32 s67, 0
L_kvf:
    buffer_load_dwordx4 v[80:83], v180, s[40:43], s77 offen sc1
    buffer_load_dwordx4 v[84:87], v246, s[40:43], s77 offen offset:1024 sc1
    buffer_load_dwordx2 v[182:183], v254, s[40:43], s1 offen sc1
    s_add_u32 s67, s67, 1
    s_cmp_ge_u32 s67, 1048576
    s_waitcnt vmcnt(0)
    s_cbranch_scc1 L_kvf_x
    v_cmp_ne_u32 vcc, s65, v83
    s_cbranch_vccnz L_kvf
    v_cmp_ne_u32 vcc, s65, v87
    s_cbranch_vccnz L_kvf
    v_cmp_ne_u32 vcc, s65, v183
    s_cbranch_vccnz L_kvf
L_kvf_x:
    s_branch L_kvf_ok
L_late:
    s_waitcnt vmcnt(0)
    buffer_store_dword v184, v226, s[40:43], s73 offen sc1
    s_mov_b32 s73, 1073741824
    s_mov_b32 s67, 0
L_h1a:
    buffer_load_dword v186, v225, s[40:43], s64 offen sc1
    s_add_u32 s67, s67, 1
    s_cmp_ge_u32 s67, 1048576
    s_waitcnt vmcnt(0)
    s_cbranch_scc1 L_h1a_x
    v_cmp_ne_u32 vcc, s65, v186
    s_cbranch_vccnz L_h1a
L_h1a_x:
    s_mul_i32 s61, s52, 22528
    buffer_load_dwordx4 v[0:3], v222, s[40:43], s61 offen offset:0 sc1
    buffer_load_dwordx4 v[4:7], v223, s[40:43], s61 offen offset:0 sc1
    buffer_load_dwordx4 v[8:11], v222, s[40:43], s61 offen offset:1024 sc1
    buffer_load_dwordx4 v[12:15], v223, s[40:43], s61 offen offset:1024 sc1
    buffer_load_dwordx4 v[16:19], v222, s[40:43], s61 offen offset:2048 sc1
    buffer_load_dwordx4 v[20:23], v223, s[40:43], s61 offen offset:2048 sc1
    buffer_load_dwordx4 v[24:27], v222, s[40:43], s61 offen offset:3072 sc1
    buffer_load_dwordx4 v[28:31], v223, s[40:43], s61 offen offset:3072 sc1
    s_add_u32 s61, s61, 4096
    buffer_load_dwordx4 v[80:83], v222, s[40:43], s61 offen offset:0 sc1
    buffer_load_dwordx4 v[84:87], v223, s[40:43], s61 offen offset:0 sc1
    buffer_load_dwordx4 v[88:91], v222, s[40:43], s61 offen offset:1024 sc1
    buffer_load_dwordx4 v[92:95], v223, s[40:43], s61 offen offset:1024 sc1
    s_branch L_late_ok
L_h2_r:
    s_mov_b32 s67, 0
L_h2:
    buffer_load_dword v186, v225, s[40:43], s64 offen sc1
    s_add_u32 s67, s67, 1
    s_cmp_ge_u32 s67, 1048576
    s_waitcnt vmcnt(0)
    s_cbranch_scc1 L_h2_x
    v_cmp_ne_u32 vcc, s65, v186
    s_cbranch_vccnz L_h2
L_h2_x:
    s_branch L_h2_ok
L_op_r:
    s_mov_b32 s67, 0
L_op:
    buffer_load_dword v186, v225, s[40:43], s74 offen sc1
    s_add_u32 s67, s67, 1
    s_cmp_ge_u32 s67, 1048576
    s_waitcnt vmcnt(0)
    s_cbranch_scc1 L_op_x
    v_cmp_ne_u32 vcc, s65, v186
    s_cbranch_vccnz L_op
L_op_x:
    s_branch L_op_ok
L_codeend:
.section .rodata,"a"
.p2align 6
.amdhsa_kernel gated_mix__linear_kernel_hedgehog__dense_activation_gelu__prompt_kernel
  .amdhsa_next_free_vgpr 512
  .amdhsa_next_free_sgpr 102
  .amdhsa_accum_offset 256
  .amdhsa_group_segment_fixed_size 0
  .amdhsa_kernarg_size 104
  .amdhsa_user_sgpr_count 2
  .amdhsa_user_sgpr_kernarg_segment_ptr 1
  .amdhsa_system_sgpr_workgroup_id_x 1
.end_amdhsa_kernel
```
